```python
import torch

def _softmax(x, axis=-1):
    return torch.softmax(x, dim=axis)
def _gelu(x):
    return torch.nn.functional.gelu(x, approximate="tanh")
def _silu(x):
    return torch.nn.functional.silu(x)
def _sigmoid(x):
    return torch.sigmoid(x)
def _layernorm(x, axis=-1, eps=1e-5):
    m = x.mean(dim=axis, keepdim=True)
    v = x.var(dim=axis, keepdim=True, unbiased=False)
    return (x - m) / torch.sqrt(v + eps)
def _scatter_add(tgt, idx, src, axis=0):
    return tgt.clone().index_add_(axis, idx, src)
def _segment_sum(src, seg, n):
    out = torch.zeros((n,) + src.shape[1:], dtype=src.dtype)
    return out.index_add_(0, seg, src)
def _pad(x, pw):
    flat = tuple(v for pair in reversed(pw) for v in pair)
    return torch.nn.functional.pad(x, flat)

kernel_name = 'sequential_preLN__ssm_conv_s4d__glu_gated_swiglu__prompt'

def setup_inputs():

    _w = (lambda a: (lambda t: t.to(torch.bfloat16) if t.is_floating_point() else t)(torch.as_tensor(a)))
    def _A_setup():
        Bsz, L, D, N = 1, 2048, 448, 256
        return {
            "u": _w((lambda *s: torch.randn(*s, dtype=torch.bfloat16) * 0.05)(Bsz, L, D)),
            "log_A_real": _w((lambda *s: torch.randn(*s, dtype=torch.bfloat16) * 6.4)(D, N) * 0.5),
            "A_imag": _w((lambda *s: torch.randn(*s, dtype=torch.bfloat16) * 0.05)(D, N) * 3.14),
            "C_real": _w((lambda *s: torch.randn(*s, dtype=torch.bfloat16) * 0.05)(D, N) / N ** 0.5),
            "C_imag": _w((lambda *s: torch.randn(*s, dtype=torch.bfloat16) * 0.05)(D, N) / N ** 0.5),
            "log_dt": _w((lambda *s: torch.randn(*s, dtype=torch.bfloat16) * 0.05)(D) * 0.5 - 4.0),
            "D_skip": _w((lambda *s: torch.randn(*s, dtype=torch.bfloat16) * 0.05)(D)),
        }
    _A_in = _A_setup()

    def _B_setup():
        B, S, D, F = 1, 2048, 448, 1792
        return {
            "x": _w((lambda *s: torch.randn(*s, dtype=torch.bfloat16) * 0.05)(B, S, D)),
            "w1": _w((lambda *s: torch.randn(*s, dtype=torch.bfloat16) * 0.4)(D, F) * (2.0 / D) ** 0.5),
            "w3": _w((lambda *s: torch.randn(*s, dtype=torch.bfloat16) * 0.4)(D, F) * (2.0 / D) ** 0.5),
            "w2": _w((lambda *s: torch.randn(*s, dtype=torch.bfloat16) * 0.4)(F, D) * (2.0 / F) ** 0.5),
        }
    _B_in = _B_setup()

    return {
        "A_u": _A_in["u"],
        "A_log_A_real": _A_in["log_A_real"],
        "A_A_imag": _A_in["A_imag"],
        "A_C_real": _A_in["C_real"],
        "A_C_imag": _A_in["C_imag"],
        "A_log_dt": _A_in["log_dt"],
        "A_D_skip": _A_in["D_skip"],
        "B_x": _B_in["x"],
        "B_w1": _B_in["w1"],
        "B_w3": _B_in["w3"],
        "B_w2": _B_in["w2"],
    }

def reference(A_u, A_log_A_real, A_A_imag, A_C_real, A_C_imag, A_log_dt, A_D_skip, B_x, B_w1, B_w3, B_w2):
    def _A_ref(u, log_A_real, A_imag, C_real, C_imag, log_dt, D_skip):
        L = u.shape[1]
        dt = torch.exp(log_dt)
        A = -torch.exp(log_A_real) + 1j * A_imag
        C = (C_real + 1j * C_imag) * dt[:, None]
        pos = (lambda x, dt: x.to(dt))(torch.arange(L), log_dt.dtype)
        P = torch.exp((A * dt[:, None])[:, :, None] * pos[None, None, :])
        K = 2.0 * torch.einsum("dn,dnl->dl", C, P).real
        L2 = 2 * L
        u_t = (lambda x, *d: x.permute(*d))(u, 0, 2, 1)
        Kf = (lambda x, *a, **k: torch.fft.rfft(x.float(), *a, **k))(K, L2)
        Uf = (lambda x, *a, **k: torch.fft.rfft(x.float(), *a, **k))(u_t, L2)
        y = (lambda x, *a, **k: torch.fft.irfft(x, *a, **k).to(torch.bfloat16))(Uf * Kf[None, :, :], L2)[:, :, :L]
        y = (lambda x, *d: x.permute(*d))(y, 0, 2, 1)
        return y + u * D_skip[None, None, :]

    def _B_ref(x, w1, w3, w2):
        gate = torch.einsum("bsd,df->bsf", x, w1)
        up = torch.einsum("bsd,df->bsf", x, w3)
        h = _silu(gate) * up
        out = torch.einsum("bsf,fd->bsd", h, w2)
        return out

    x = A_u
    h = x + _A_ref(_layernorm(x, axis=-1), A_log_A_real, A_A_imag, A_C_real, A_C_imag, A_log_dt, A_D_skip)
    h2 = h + _B_ref(_layernorm(h, axis=-1), B_w1, B_w3, B_w2)
    return h2
```

```asm
; @launch grid=(256,1,1) block=(512,1,1) lds=163840
.amdgcn_target "amdgcn-amd-amdhsa--gfx950"
.text
.globl sequential_preLN__ssm_conv_s4d__glu_gated_swiglu__prompt_kernel
.p2align 8
.type sequential_preLN__ssm_conv_s4d__glu_gated_swiglu__prompt_kernel,@function
sequential_preLN__ssm_conv_s4d__glu_gated_swiglu__prompt_kernel:
KERNEL_START:
    s_cmp_ge_u32 s2, 256
    s_cbranch_scc1 L_end
    s_load_dwordx16 s[4:19], s[0:1], 0
    s_load_dwordx8 s[20:27], s[0:1], 64
    s_load_dwordx4 s[28:31], s[0:1], 96
    v_and_b32 v1, 63, v0
    v_lshrrev_b32 v2, 6, v0
    s_nop 0
    v_readfirstlane_b32 s32, v2
    s_waitcnt lgkmcnt(0)
    s_mov_b32 s56, s30
    s_mov_b32 s57, s31
    s_mov_b32 s58, 16777216
    s_mov_b32 s59, 0x20000
    s_mov_b32 s60, s28
    s_mov_b32 s61, s29
    s_mov_b32 s62, 256
    s_mov_b32 s63, 0x20000
    s_or_b32 s64, s2, s32
    s_cmp_eq_u32 s64, 0
    s_cbranch_scc0 L_nopub
    s_memrealtime s[64:65]
    s_waitcnt lgkmcnt(0)
    s_or_b32 s64, s64, 1
    v_mov_b32 v3, s64
    v_mov_b32 v4, 0
    buffer_store_dword v3, v4, s[60:63], 0 offen sc1
L_nopub:
    s_cmp_ge_u32 s2, 224
    s_cbranch_scc1 L_helper
    s_lshr_b32 s34, s32, 2
    s_and_b32 s35, s32, 3
    s_mov_b32 s36, s4
    s_mov_b32 s37, s5
    s_mov_b32 s38, 1835008
    s_mov_b32 s39, 0x20000
    s_lshl_b32 s64, s2, 3
    s_add_u32 s64, s64, s32
    s_mul_i32 s64, s64, 896
    v_lshl_add_u32 v194, v1, 4, s64
    v_mov_b32 v196, 0
    v_mov_b32 v197, 0
    v_mov_b32 v198, 0
    v_mov_b32 v199, 0
    v_cmp_gt_u32 vcc, 56, v1
    s_nop 3
    s_and_saveexec_b64 s[66:67], vcc
    buffer_load_dwordx4 v[196:199], v194, s[36:39], 0 offen
    s_mov_b64 exec, s[66:67]
    v_mov_b32 v193, 0
    buffer_load_dword v195, v193, s[60:63], 0 offen sc1
    s_mov_b32 s40, s6
    s_mov_b32 s41, s7
    s_mov_b32 s42, 229376
    s_mov_b32 s43, 0x20000
    s_mov_b32 s44, s8
    s_mov_b32 s45, s9
    s_mov_b32 s46, 229376
    s_mov_b32 s47, 0x20000
    s_mov_b32 s48, s10
    s_mov_b32 s49, s11
    s_mov_b32 s50, 229376
    s_mov_b32 s51, 0x20000
    s_mov_b32 s52, s12
    s_mov_b32 s53, s13
    s_mov_b32 s54, 229376
    s_mov_b32 s55, 0x20000
    s_and_b32 s64, s2, 7
    s_mul_i32 s64, s64, 28
    s_lshr_b32 s65, s2, 3
    s_add_u32 s75, s64, s65
    s_lshl_b32 s64, s75, 2
    s_load_dword s68, s[14:15], s64
    s_load_dword s69, s[16:17], s64
    s_lshl_b32 s70, s75, 1
    s_add_u32 s70, s70, s34
    s_lshl_b32 s65, s70, 9
    s_lshl_b32 s66, s35, 7
    s_add_u32 s65, s65, s66
    v_lshl_add_u32 v3, v1, 1, s65
    buffer_load_ushort v10, v3, s[40:43], 0 offen
    buffer_load_ushort v11, v3, s[44:47], 0 offen
    buffer_load_ushort v12, v3, s[48:51], 0 offen
    buffer_load_ushort v13, v3, s[52:55], 0 offen
    s_getpc_b64 s[64:65]
L_pc_89:
    s_sub_u32 s64, s64, L_pc_89-KERNEL_START
    s_subb_u32 s65, s65, 0
    v_lshrrev_b32 v178, 1, v0
    v_lshlrev_b32 v178, 7, v178
    v_min_u32 v178, KERNEL_END-KERNEL_START-4, v178
    global_load_dword v177, v178, s[64:65]
    v_lshlrev_b32 v7, 4, v0
    v_add_u32 v7, 114688, v7
    v_mov_b32 v20, 0
    v_mov_b32 v21, 0
    v_mov_b32 v22, 0
    v_mov_b32 v23, 0
    v_cmp_gt_u32 vcc, 30, v0
    s_nop 3
    s_and_saveexec_b64 s[66:67], vcc
    ds_write_b128 v7, v[20:23] offset:2624
    ds_write_b128 v7, v[20:23] offset:7200
    s_mov_b64 exec, s[66:67]
    v_and_b32 v8, 255, v0
    v_lshlrev_b32 v9, 3, v8
    v_sub_u32 v9, 2047, v9
    v_subrev_u32 v30, 0, v9
    v_subrev_u32 v31, 1, v9
    v_subrev_u32 v32, 2, v9
    v_subrev_u32 v33, 3, v9
    v_subrev_u32 v34, 4, v9
    v_subrev_u32 v35, 5, v9
    v_subrev_u32 v36, 6, v9
    v_subrev_u32 v37, 7, v9
    v_subrev_u32 v38, 8, v9
    v_subrev_u32 v39, 9, v9
    v_subrev_u32 v40, 10, v9
    v_cvt_f32_i32 v44, v30
    v_cvt_f32_i32 v45, v31
    v_cvt_pk_bf16_f32 v58, v44, v45
    v_cvt_f32_i32 v46, v32
    v_cvt_f32_i32 v47, v33
    v_cvt_pk_bf16_f32 v59, v46, v47
    v_cvt_f32_i32 v48, v34
    v_cvt_f32_i32 v49, v35
    v_cvt_pk_bf16_f32 v60, v48, v49
    v_cvt_f32_i32 v50, v36
    v_cvt_f32_i32 v51, v37
    v_cvt_pk_bf16_f32 v61, v50, v51
    v_cvt_f32_i32 v52, v38
    v_cvt_f32_i32 v53, v39
    v_cvt_pk_bf16_f32 v62, v52, v53
    v_cvt_f32_i32 v54, v40
    v_cvt_pk_bf16_f32 v63, v54, v54
    v_and_b32 v226, 0xffff, v58
    v_subrev_u32 v226, 17024, v226
    v_min_i32 v30, 128, v30
    v_max_i32 v226, v226, v30
    v_lshrrev_b32 v227, 16, v58
    v_subrev_u32 v227, 17024, v227
    v_min_i32 v31, 128, v31
    v_max_i32 v227, v227, v31
    v_and_b32 v228, 0xffff, v59
    v_subrev_u32 v228, 17024, v228
    v_min_i32 v32, 128, v32
    v_max_i32 v228, v228, v32
    v_lshrrev_b32 v229, 16, v59
    v_subrev_u32 v229, 17024, v229
    v_min_i32 v33, 128, v33
    v_max_i32 v229, v229, v33
    v_and_b32 v230, 0xffff, v60
    v_subrev_u32 v230, 17024, v230
    v_min_i32 v34, 128, v34
    v_max_i32 v230, v230, v34
    v_lshrrev_b32 v231, 16, v60
    v_subrev_u32 v231, 17024, v231
    v_min_i32 v35, 128, v35
    v_max_i32 v231, v231, v35
    v_and_b32 v232, 0xffff, v61
    v_subrev_u32 v232, 17024, v232
    v_min_i32 v36, 128, v36
    v_max_i32 v232, v232, v36
    v_lshrrev_b32 v233, 16, v61
    v_subrev_u32 v233, 17024, v233
    v_min_i32 v37, 128, v37
    v_max_i32 v233, v233, v37
    v_and_b32 v234, 0xffff, v62
    v_subrev_u32 v234, 17024, v234
    v_min_i32 v38, 128, v38
    v_max_i32 v234, v234, v38
    v_lshrrev_b32 v235, 16, v62
    v_subrev_u32 v235, 17024, v235
    v_min_i32 v39, 128, v39
    v_max_i32 v235, v235, v39
    v_and_b32 v236, 0xffff, v63
    v_subrev_u32 v236, 17024, v236
    v_min_i32 v40, 128, v40
    v_max_i32 v236, v236, v40
    v_mov_b32 v64, 641
    v_cmp_gt_i32 vcc, 8, v9
    s_nop 1
    v_cndmask_b32 v234, v234, v64, vcc
    v_cmp_gt_i32 vcc, 9, v9
    s_nop 1
    v_cndmask_b32 v235, v235, v64, vcc
    v_cmp_gt_i32 vcc, 10, v9
    s_nop 1
    v_cndmask_b32 v236, v236, v64, vcc
    s_mul_i32 s66, s34, 1312
    s_add_u32 s72, s66, 114688
    v_mov_b32 v65, s72
    v_lshl_add_u32 v226, v226, 1, v65
    v_lshl_add_u32 v227, v227, 1, v65
    v_lshl_add_u32 v228, v228, 1, v65
    v_lshl_add_u32 v229, v229, 1, v65
    v_lshl_add_u32 v230, v230, 1, v65
    v_lshl_add_u32 v231, v231, 1, v65
    v_lshl_add_u32 v232, v232, 1, v65
    v_lshl_add_u32 v233, v233, 1, v65
    v_lshl_add_u32 v234, v234, 1, v65
    v_lshl_add_u32 v235, v235, 1, v65
    v_lshl_add_u32 v236, v236, 1, v65
    s_mul_i32 s66, s34, 16640
    s_add_u32 s66, s66, 32
    v_lshl_add_u32 v237, v8, 4, s66
    v_and_b32 v9, 15, v1
    v_lshrrev_b32 v8, 4, v1
    s_and_b32 s73, s32, 1
    s_bfe_u32 s74, s32, 0x10001
    s_lshl_b32 s65, s73, 4
    v_add_u32 v30, s65, v9
    v_lshlrev_b32 v31, 4, v30
    v_lshl_add_u32 v31, v8, 3, v31
    v_lshlrev_b32 v32, 3, v30
    v_add_u32 v32, 512, v32
    v_cmp_eq_u32 vcc, 2, v8
    s_nop 1
    v_cndmask_b32 v31, v31, v32, vcc
    v_lshlrev_b32 v32, 2, v30
    v_add_u32 v32, 768, v32
    v_add_u32 v33, 4, v31
    v_add_u32 v34, 128, v32
    v_cmp_eq_u32 vcc, 3, v8
    s_nop 1
    v_cndmask_b32 v31, v31, v32, vcc
    v_cndmask_b32 v33, v33, v34, vcc
    v_lshlrev_b32 v32, 1, v30
    v_add_u32 v32, 1024, v32
    v_mov_b32 v34, 1288
    v_cmp_eq_u32 vcc, 0, v8
    v_add_u32 v35, 0, v32
    s_nop 0
    v_cndmask_b32 v238, v34, v35, vcc
    v_add_u32 v35, 64, v32
    v_cndmask_b32 v239, v34, v35, vcc
    v_add_u32 v35, 128, v32
    v_cndmask_b32 v240, v34, v35, vcc
    v_add_u32 v35, 192, v32
    v_cndmask_b32 v241, v34, v35, vcc
    v_lshl_add_u32 v35, v8, 8, v30
    v_mov_b32 v36, 1280
    v_cmp_eq_u32 vcc, 0x100, v35
    s_nop 1
    v_cndmask_b32 v238, v238, v36, vcc
    s_cmp_eq_u32 s74, 0
    s_cbranch_scc0 L_tb_rt1
    v_mov_b32 v238, v31
    v_mov_b32 v239, v33
L_tb_rt1:
    v_add_u32 v238, s72, v238
    v_add_u32 v239, s72, v239
    v_add_u32 v240, s72, v240
    v_add_u32 v241, s72, v241
    v_mov_b32 v36, s72
    ds_write_b16 v36, v20 offset:1282
    s_movk_i32 s65, 1056
    v_mul_lo_u32 v248, v9, s65
    v_lshl_add_u32 v248, v8, 4, v248
    s_mul_i32 s66, s34, 55968
    v_add_u32 v248, s66, v248
    s_mul_i32 s67, s73, 16896
    s_add_u32 s67, s67, 22176
    v_add_u32 v249, s67, v248
    s_mul_i32 s67, s74, 16896
    v_add_u32 v248, s67, v248
    v_sub_u32 v30, 3, v9
    v_and_b32 v30, 3, v30
    s_movk_i32 s65, 4160
    v_mul_lo_u32 v31, v30, s65
    v_lshlrev_b32 v32, 3, v8
    v_sub_u32 v32, v32, v9
    v_sub_u32 v32, v32, v30
    v_add_u32 v32, 2047, v32
    v_lshl_add_u32 v31, v32, 1, v31
    s_mul_i32 s66, s34, 16640
    s_sub_u32 s66, s66, 4032
    v_add_u32 v244, s66, v31
    s_mul_i32 s66, s34, 4576
    s_add_u32 s66, s66, 117312
    v_lshlrev_b32 v31, 5, v9
    v_lshl_add_u32 v31, v8, 4, v31
    v_add_u32 v245, s66, v31
    s_mul_i32 s66, s34, 8192
    s_add_u32 s66, s66, 126464
    v_lshlrev_b32 v31, 6, v9
    v_lshl_add_u32 v31, v8, 4, v31
    v_add_u32 v246, s66, v31
    s_mul_i32 s66, s70, 4352
    s_add_u32 s66, s66, 131072
    v_lshlrev_b32 v31, 5, v9
    v_lshl_add_u32 v31, v8, 3, v31
    v_add_u32 v247, s66, v31
    s_mul_i32 s71, s34, 55968
    s_lshl_b32 s66, s35, 8
    s_add_u32 s71, s71, s66
    s_waitcnt lgkmcnt(0)
    s_lshl_b32 s65, s34, 4
    s_lshr_b32 s66, s68, s65
    s_lshl_b32 s66, s66, 16
    v_mov_b32 v14, 0x3fb8aa3b
    v_mul_f32 v15, s66, v14
    v_exp_f32 v15, v15
    s_nop 0
    v_cvt_pk_bf16_f32 v15, v15, v15
    v_lshlrev_b32 v15, 16, v15
    s_mov_b32 m0, s71
    s_waitcnt vmcnt(6)
    s_mul_i32 s64, s32, 912
    s_add_u32 s64, s64, 142848
    v_lshl_add_u32 v194, v1, 4, s64
    v_cmp_gt_u32 vcc, 56, v1
    s_nop 3
    s_and_saveexec_b64 s[66:67], vcc
    ds_write_b128 v194, v[196:199]
    s_mov_b64 exec, s[66:67]
    v_bfe_u32 v184, v1, 2, 2
    v_mul_u32_u24 v184, 912, v184
    v_lshrrev_b32 v185, 4, v1
    v_lshl_add_u32 v184, v185, 5, v184
    v_and_b32 v185, 3, v1
    v_lshl_add_u32 v184, v185, 3, v184
    s_lshl_b32 s64, s32, 7
    s_add_u32 s64, s64, 142848
    v_add_u32 v184, s64, v184
    s_mul_i32 s64, s2, 7168
    s_lshl_b32 s65, s32, 10
    s_add_u32 s64, s64, s65
    s_add_u32 s64, s64, 2097152
    v_lshl_add_u32 v185, v1, 4, s64
    s_waitcnt lgkmcnt(0)
    s_barrier
    s_cmp_ge_u32 s32, 7
    s_cbranch_scc1 L_xp_notr_m
    ds_read_b64_tr_b16 v[180:181], v184
    ds_read_b64_tr_b16 v[182:183], v184 offset:3648
    s_waitcnt lgkmcnt(0)
    buffer_store_dwordx4 v[180:183], v185, s[56:59], 0 offen sc1
L_xp_notr_m:
    v_mov_b32 v190, 0x3f803f80
    v_mov_b32 v188, 0
    v_mov_b32 v189, 0
    v_dot2_f32_bf16 v188, v196, v190, v188
    v_dot2_f32_bf16 v189, v196, v196, v189
    v_dot2_f32_bf16 v188, v197, v190, v188
    v_dot2_f32_bf16 v189, v197, v197, v189
    v_dot2_f32_bf16 v188, v198, v190, v188
    v_dot2_f32_bf16 v189, v198, v198, v189
    v_dot2_f32_bf16 v188, v199, v190, v188
    v_dot2_f32_bf16 v189, v199, v199, v189
    s_nop 1
    v_add_f32_dpp v188, v188, v188 quad_perm:[1,0,3,2] row_mask:0xf bank_mask:0xf
    v_add_f32_dpp v189, v189, v189 quad_perm:[1,0,3,2] row_mask:0xf bank_mask:0xf
    s_nop 0
    v_add_f32_dpp v188, v188, v188 quad_perm:[2,3,0,1] row_mask:0xf bank_mask:0xf
    v_add_f32_dpp v189, v189, v189 quad_perm:[2,3,0,1] row_mask:0xf bank_mask:0xf
    s_nop 0
    v_add_f32_dpp v188, v188, v188 row_half_mirror row_mask:0xf bank_mask:0xf
    v_add_f32_dpp v189, v189, v189 row_half_mirror row_mask:0xf bank_mask:0xf
    s_nop 0
    v_add_f32_dpp v188, v188, v188 row_mirror row_mask:0xf bank_mask:0xf
    v_add_f32_dpp v189, v189, v189 row_mirror row_mask:0xf bank_mask:0xf
    v_mov_b32 v186, v188
    v_mov_b32 v187, v189
    s_nop 0
    v_permlane16_swap_b32 v188, v186
    v_permlane16_swap_b32 v189, v187
    v_add_f32 v188, v188, v186
    v_add_f32 v189, v189, v187
    v_mov_b32 v186, v188
    v_mov_b32 v187, v189
    s_nop 0
    v_permlane32_swap_b32 v188, v186
    v_permlane32_swap_b32 v189, v187
    v_add_f32 v188, v188, v186
    v_add_f32 v189, v189, v187
    v_mul_f32 v188, 0x3b124925, v188
    v_mul_f32 v189, 0x3b124925, v189
    v_fma_f32 v189, -v188, v188, v189
    v_max_f32 v189, 0, v189
    v_cvt_pk_bf16_f32 v184, v189, v188
    v_lshlrev_b32 v185, 16, v184
    v_add_f32 v185, 0x3727c5ac, v185
    v_cvt_pk_bf16_f32 v185, v185, v185
    v_lshlrev_b32 v185, 16, v185
    v_sqrt_f32 v185, v185
    s_nop 0
    v_cvt_pk_bf16_f32 v185, v185, v185
    v_lshrrev_b32 v184, 16, v184
    v_and_b32 v185, 0xffff0000, v185
    v_or_b32 v186, v184, v185
    v_and_b32 v187, 0xffff0000, v186
    v_lshlrev_b32 v186, 16, v186
    v_rcp_f32 v188, v187
    s_nop 0
    v_mul_f32_e64 v189, -v186, v188
    s_lshl_b32 s64, s2, 6
    s_lshl_b32 s65, s32, 3
    s_add_u32 s64, s64, s65
    v_mov_b32 v187, s64
    s_mov_b64 exec, 1
    buffer_store_dwordx2 v[188:189], v187, s[56:59], 0 offen offset:0 sc1
    s_mov_b64 exec, -1
    s_waitcnt vmcnt(2)
    s_mov_b32 m0, s71
    v_lshlrev_b32 v16, 16, v10
    v_lshlrev_b32 v24, 16, v11
    v_mul_f32 v16, v14, v16
    v_mul_f32 v24, v24, v15
    v_exp_f32 v16, v16
    v_mul_f32 v24, 0x3e22f983, v24
    v_lshlrev_b32 v30, 16, v12
    v_lshlrev_b32 v31, 16, v13
    v_cvt_pk_bf16_f32 v16, v16, v16
    v_add_f32 v26, v15, v15
    v_lshlrev_b32 v18, 16, v16
    v_mul_f32 v30, v30, v26
    v_mul_f32_e64 v31, -v31, v26
    v_mul_f32 v18, v18, v15
    v_mul_f32_e64 v18, -v18, v14
    v_mul_f32 v60, 0x41000000, v18
    v_mul_f32 v61, 0x41000000, v24
    v_exp_f32 v60, v60
    v_fract_f32 v61, v61
    v_exp_f32 v62, v18
    v_fract_f32 v63, v24
    v_mul_f32 v64, 0x43800000, v18
    v_mul_f32 v65, 0x43800000, v24
    v_exp_f32 v64, v64
    v_fract_f32 v65, v65
    v_cos_f32 v44, v61
    v_sin_f32 v45, v61
    v_cos_f32 v40, v63
    v_sin_f32 v41, v63
    v_cos_f32 v48, v65
    v_sin_f32 v49, v65
    v_mul_f32 v44, v44, v60
    v_mul_f32 v45, v45, v60
    v_mul_f32 v40, v40, v62
    v_mul_f32 v41, v41, v62
    v_mul_f32 v48, v48, v64
    v_mul_f32 v49, v49, v64
    v_cvt_pk_bf16_f32 v80, v30, v31
    ds_write_addtid_b32 v80 offset:0
    v_cvt_pk_bf16_f32 v81, v44, v45
    ds_write_addtid_b32 v81 offset:23232
    v_mov_b32 v108, 0x3f80
    ds_write_addtid_b32 v108 offset:22176
    v_pk_mul_f32 v[72:73], v[40:41], v[40:41] op_sel:[0,0] op_sel_hi:[1,0]
    v_pk_fma_f32 v[52:53], v[40:41], v[40:41], v[72:73] op_sel:[1,1,0] op_sel_hi:[0,1,1] neg_lo:[1,0,0]
    v_pk_mul_f32 v[72:73], v[52:53], v[52:53] op_sel:[0,0] op_sel_hi:[1,0]
    v_pk_fma_f32 v[56:57], v[52:53], v[52:53], v[72:73] op_sel:[1,1,0] op_sel_hi:[0,1,1] neg_lo:[1,0,0]
    v_pk_mul_f32 v[72:73], v[44:45], v[44:45] op_sel:[0,0] op_sel_hi:[1,0]
    v_pk_mul_f32 v[76:77], v[30:31], v[40:41] op_sel:[0,0] op_sel_hi:[1,0]
    v_pk_fma_f32 v[88:89], v[44:45], v[44:45], v[72:73] op_sel:[1,1,0] op_sel_hi:[0,1,1] neg_lo:[1,0,0]
    v_pk_fma_f32 v[34:35], v[30:31], v[40:41], v[76:77] op_sel:[1,1,0] op_sel_hi:[0,1,1] neg_hi:[1,0,0]
    v_cvt_pk_bf16_f32 v82, v88, v89
    ds_write_addtid_b32 v82 offset:24288
    v_cvt_pk_bf16_f32 v83, v34, v35
    ds_write_addtid_b32 v83 offset:1056
    v_pk_mul_f32 v[72:73], v[88:89], v[44:45] op_sel:[0,0] op_sel_hi:[1,0]
    v_pk_mul_f32 v[76:77], v[34:35], v[40:41] op_sel:[0,0] op_sel_hi:[1,0]
    v_pk_fma_f32 v[88:89], v[88:89], v[44:45], v[72:73] op_sel:[1,1,0] op_sel_hi:[0,1,1] neg_lo:[1,0,0]
    v_pk_fma_f32 v[34:35], v[34:35], v[40:41], v[76:77] op_sel:[1,1,0] op_sel_hi:[0,1,1] neg_hi:[1,0,0]
    v_cvt_pk_bf16_f32 v84, v88, v89
    ds_write_addtid_b32 v84 offset:25344
    v_cvt_pk_bf16_f32 v85, v34, v35
    ds_write_addtid_b32 v85 offset:2112
    v_pk_mul_f32 v[72:73], v[88:89], v[44:45] op_sel:[0,0] op_sel_hi:[1,0]
    v_pk_mul_f32 v[76:77], v[34:35], v[40:41] op_sel:[0,0] op_sel_hi:[1,0]
    v_pk_fma_f32 v[88:89], v[88:89], v[44:45], v[72:73] op_sel:[1,1,0] op_sel_hi:[0,1,1] neg_lo:[1,0,0]
    v_pk_fma_f32 v[34:35], v[34:35], v[40:41], v[76:77] op_sel:[1,1,0] op_sel_hi:[0,1,1] neg_hi:[1,0,0]
    v_cvt_pk_bf16_f32 v80, v88, v89
    ds_write_addtid_b32 v80 offset:26400
    v_cvt_pk_bf16_f32 v81, v34, v35
    ds_write_addtid_b32 v81 offset:3168
    v_pk_mul_f32 v[72:73], v[88:89], v[44:45] op_sel:[0,0] op_sel_hi:[1,0]
    v_pk_mul_f32 v[76:77], v[34:35], v[40:41] op_sel:[0,0] op_sel_hi:[1,0]
    v_pk_fma_f32 v[88:89], v[88:89], v[44:45], v[72:73] op_sel:[1,1,0] op_sel_hi:[0,1,1] neg_lo:[1,0,0]
    v_pk_fma_f32 v[34:35], v[34:35], v[40:41], v[76:77] op_sel:[1,1,0] op_sel_hi:[0,1,1] neg_hi:[1,0,0]
    v_cvt_pk_bf16_f32 v82, v88, v89
    ds_write_addtid_b32 v82 offset:27456
    v_cvt_pk_bf16_f32 v83, v34, v35
    ds_write_addtid_b32 v83 offset:4224
    v_pk_mul_f32 v[72:73], v[88:89], v[44:45] op_sel:[0,0] op_sel_hi:[1,0]
    v_pk_mul_f32 v[76:77], v[34:35], v[40:41] op_sel:[0,0] op_sel_hi:[1,0]
    v_pk_fma_f32 v[88:89], v[88:89], v[44:45], v[72:73] op_sel:[1,1,0] op_sel_hi:[0,1,1] neg_lo:[1,0,0]
    v_pk_fma_f32 v[34:35], v[34:35], v[40:41], v[76:77] op_sel:[1,1,0] op_sel_hi:[0,1,1] neg_hi:[1,0,0]
    v_cvt_pk_bf16_f32 v84, v88, v89
    ds_write_addtid_b32 v84 offset:28512
    v_cvt_pk_bf16_f32 v85, v34, v35
    ds_write_addtid_b32 v85 offset:5280
    v_pk_mul_f32 v[72:73], v[88:89], v[44:45] op_sel:[0,0] op_sel_hi:[1,0]
    v_pk_mul_f32 v[76:77], v[34:35], v[40:41] op_sel:[0,0] op_sel_hi:[1,0]
    v_pk_fma_f32 v[88:89], v[88:89], v[44:45], v[72:73] op_sel:[1,1,0] op_sel_hi:[0,1,1] neg_lo:[1,0,0]
    v_pk_fma_f32 v[34:35], v[34:35], v[40:41], v[76:77] op_sel:[1,1,0] op_sel_hi:[0,1,1] neg_hi:[1,0,0]
    v_cvt_pk_bf16_f32 v80, v88, v89
    ds_write_addtid_b32 v80 offset:29568
    v_cvt_pk_bf16_f32 v81, v34, v35
    ds_write_addtid_b32 v81 offset:6336
    v_pk_mul_f32 v[72:73], v[88:89], v[44:45] op_sel:[0,0] op_sel_hi:[1,0]
    v_pk_mul_f32 v[76:77], v[34:35], v[40:41] op_sel:[0,0] op_sel_hi:[1,0]
    v_pk_fma_f32 v[88:89], v[88:89], v[44:45], v[72:73] op_sel:[1,1,0] op_sel_hi:[0,1,1] neg_lo:[1,0,0]
    v_pk_fma_f32 v[34:35], v[34:35], v[40:41], v[76:77] op_sel:[1,1,0] op_sel_hi:[0,1,1] neg_hi:[1,0,0]
    v_cvt_pk_bf16_f32 v82, v88, v89
    ds_write_addtid_b32 v82 offset:30624
    v_cvt_pk_bf16_f32 v83, v34, v35
    ds_write_addtid_b32 v83 offset:7392
    v_pk_mul_f32 v[72:73], v[88:89], v[44:45] op_sel:[0,0] op_sel_hi:[1,0]
    v_pk_mul_f32 v[76:77], v[30:31], v[48:49] op_sel:[0,0] op_sel_hi:[1,0]
    v_pk_fma_f32 v[88:89], v[88:89], v[44:45], v[72:73] op_sel:[1,1,0] op_sel_hi:[0,1,1] neg_lo:[1,0,0]
    v_pk_fma_f32 v[92:93], v[30:31], v[48:49], v[76:77] op_sel:[1,1,0] op_sel_hi:[0,1,1] neg_hi:[1,0,0]
    v_cvt_pk_bf16_f32 v84, v88, v89
    ds_write_addtid_b32 v84 offset:31680
    v_cvt_pk_bf16_f32 v85, v92, v93
    ds_write_addtid_b32 v85 offset:8448
    v_pk_mul_f32 v[72:73], v[88:89], v[44:45] op_sel:[0,0] op_sel_hi:[1,0]
    v_pk_mul_f32 v[76:77], v[92:93], v[52:53] op_sel:[0,0] op_sel_hi:[1,0]
    v_pk_fma_f32 v[88:89], v[88:89], v[44:45], v[72:73] op_sel:[1,1,0] op_sel_hi:[0,1,1] neg_lo:[1,0,0]
    v_pk_fma_f32 v[104:105], v[92:93], v[52:53], v[76:77] op_sel:[1,1,0] op_sel_hi:[0,1,1] neg_hi:[1,0,0]
    v_cvt_pk_bf16_f32 v80, v88, v89
    ds_write_addtid_b32 v80 offset:32736
    v_cvt_pk_bf16_f32 v81, v104, v105
    ds_write_addtid_b32 v81 offset:9504
    s_waitcnt vmcnt(0)
    v_readfirstlane_b32 s33, v195
    s_nop 3
    s_cmp_eq_u32 s33, 0
    s_cbranch_scc0 L_xp_got_m
    v_mov_b32 v195, 0
    s_mov_b32 s66, 0
L_nonce_xpm:
    buffer_load_dword v194, v195, s[60:63], 0 offen sc1
    s_waitcnt vmcnt(0)
    v_readfirstlane_b32 s33, v194
    s_add_u32 s66, s66, 1
    s_cmp_gt_u32 s66, 30000
    s_cbranch_scc1 L_nonce_xpm_ok
    s_nop 0
    s_cmp_eq_u32 s33, 0
    s_cbranch_scc1 L_nonce_xpm
L_nonce_xpm_ok:
L_xp_got_m:
L_xp_have_m:
    s_barrier
    s_lshl_b32 s64, s2, 6
    s_add_u32 s64, s64, 98304
    s_cmp_eq_u32 s32, 0
    s_cbranch_scc0 L_pub_531
    v_mov_b32 v194, s33
    v_mov_b32 v195, s64
    s_mov_b64 exec, 1
    buffer_store_dword v194, v195, s[56:59], 0 offen sc1
    s_mov_b64 exec, -1
L_pub_531:
    v_pk_mul_f32 v[72:73], v[88:89], v[44:45] op_sel:[0,0] op_sel_hi:[1,0]
    v_pk_mul_f32 v[76:77], v[104:105], v[52:53] op_sel:[0,0] op_sel_hi:[1,0]
    v_pk_fma_f32 v[88:89], v[88:89], v[44:45], v[72:73] op_sel:[1,1,0] op_sel_hi:[0,1,1] neg_lo:[1,0,0]
    v_pk_fma_f32 v[104:105], v[104:105], v[52:53], v[76:77] op_sel:[1,1,0] op_sel_hi:[0,1,1] neg_hi:[1,0,0]
    v_cvt_pk_bf16_f32 v82, v88, v89
    ds_write_addtid_b32 v82 offset:33792
    v_cvt_pk_bf16_f32 v83, v104, v105
    ds_write_addtid_b32 v83 offset:10560
    v_pk_mul_f32 v[72:73], v[88:89], v[44:45] op_sel:[0,0] op_sel_hi:[1,0]
    v_pk_mul_f32 v[76:77], v[104:105], v[52:53] op_sel:[0,0] op_sel_hi:[1,0]
    v_pk_fma_f32 v[88:89], v[88:89], v[44:45], v[72:73] op_sel:[1,1,0] op_sel_hi:[0,1,1] neg_lo:[1,0,0]
    v_pk_fma_f32 v[104:105], v[104:105], v[52:53], v[76:77] op_sel:[1,1,0] op_sel_hi:[0,1,1] neg_hi:[1,0,0]
    v_cvt_pk_bf16_f32 v84, v88, v89
    ds_write_addtid_b32 v84 offset:34848
    v_cvt_pk_bf16_f32 v85, v104, v105
    ds_write_addtid_b32 v85 offset:11616
    v_pk_mul_f32 v[72:73], v[88:89], v[44:45] op_sel:[0,0] op_sel_hi:[1,0]
    v_pk_mul_f32 v[76:77], v[92:93], v[48:49] op_sel:[0,0] op_sel_hi:[1,0]
    v_pk_fma_f32 v[88:89], v[88:89], v[44:45], v[72:73] op_sel:[1,1,0] op_sel_hi:[0,1,1] neg_lo:[1,0,0]
    v_pk_fma_f32 v[96:97], v[92:93], v[48:49], v[76:77] op_sel:[1,1,0] op_sel_hi:[0,1,1] neg_hi:[1,0,0]
    v_cvt_pk_bf16_f32 v80, v88, v89
    ds_write_addtid_b32 v80 offset:35904
    v_cvt_pk_bf16_f32 v81, v96, v97
    ds_write_addtid_b32 v81 offset:12672
    v_pk_mul_f32 v[72:73], v[88:89], v[44:45] op_sel:[0,0] op_sel_hi:[1,0]
    v_pk_mul_f32 v[76:77], v[96:97], v[56:57] op_sel:[0,0] op_sel_hi:[1,0]
    v_pk_fma_f32 v[88:89], v[88:89], v[44:45], v[72:73] op_sel:[1,1,0] op_sel_hi:[0,1,1] neg_lo:[1,0,0]
    v_pk_fma_f32 v[104:105], v[96:97], v[56:57], v[76:77] op_sel:[1,1,0] op_sel_hi:[0,1,1] neg_hi:[1,0,0]
    v_cvt_pk_bf16_f32 v82, v88, v89
    ds_write_addtid_b32 v82 offset:36960
    v_cvt_pk_bf16_f32 v83, v104, v105
    ds_write_addtid_b32 v83 offset:13728
    v_pk_mul_f32 v[72:73], v[88:89], v[44:45] op_sel:[0,0] op_sel_hi:[1,0]
    v_pk_mul_f32 v[76:77], v[96:97], v[48:49] op_sel:[0,0] op_sel_hi:[1,0]
    v_pk_fma_f32 v[88:89], v[88:89], v[44:45], v[72:73] op_sel:[1,1,0] op_sel_hi:[0,1,1] neg_lo:[1,0,0]
    v_pk_fma_f32 v[100:101], v[96:97], v[48:49], v[76:77] op_sel:[1,1,0] op_sel_hi:[0,1,1] neg_hi:[1,0,0]
    v_cvt_pk_bf16_f32 v84, v88, v89
    ds_write_addtid_b32 v84 offset:38016
    v_cvt_pk_bf16_f32 v85, v100, v101
    ds_write_addtid_b32 v85 offset:14784
    v_pk_mul_f32 v[72:73], v[88:89], v[44:45] op_sel:[0,0] op_sel_hi:[1,0]
    v_pk_mul_f32 v[76:77], v[100:101], v[56:57] op_sel:[0,0] op_sel_hi:[1,0]
    v_pk_fma_f32 v[88:89], v[88:89], v[44:45], v[72:73] op_sel:[1,1,0] op_sel_hi:[0,1,1] neg_lo:[1,0,0]
    v_pk_fma_f32 v[104:105], v[100:101], v[56:57], v[76:77] op_sel:[1,1,0] op_sel_hi:[0,1,1] neg_hi:[1,0,0]
    v_cvt_pk_bf16_f32 v80, v88, v89
    ds_write_addtid_b32 v80 offset:39072
    v_cvt_pk_bf16_f32 v81, v104, v105
    ds_write_addtid_b32 v81 offset:15840
    v_pk_mul_f32 v[72:73], v[88:89], v[44:45] op_sel:[0,0] op_sel_hi:[1,0]
    v_pk_mul_f32 v[76:77], v[100:101], v[48:49] op_sel:[0,0] op_sel_hi:[1,0]
    v_pk_fma_f32 v[88:89], v[88:89], v[44:45], v[72:73] op_sel:[1,1,0] op_sel_hi:[0,1,1] neg_lo:[1,0,0]
    v_pk_fma_f32 v[104:105], v[100:101], v[48:49], v[76:77] op_sel:[1,1,0] op_sel_hi:[0,1,1] neg_hi:[1,0,0]
    v_cvt_pk_bf16_f32 v82, v88, v89
    ds_write_addtid_b32 v82 offset:40128
    v_cvt_pk_bf16_f32 v83, v104, v105
    ds_write_addtid_b32 v83 offset:16896
    v_pk_mul_f32 v[72:73], v[88:89], v[44:45] op_sel:[0,0] op_sel_hi:[1,0]
    v_pk_mul_f32 v[76:77], v[104:105], v[48:49] op_sel:[0,0] op_sel_hi:[1,0]
    v_pk_fma_f32 v[88:89], v[88:89], v[44:45], v[72:73] op_sel:[1,1,0] op_sel_hi:[0,1,1] neg_lo:[1,0,0]
    v_pk_fma_f32 v[104:105], v[104:105], v[48:49], v[76:77] op_sel:[1,1,0] op_sel_hi:[0,1,1] neg_hi:[1,0,0]
    v_cvt_pk_bf16_f32 v84, v88, v89
    ds_write_addtid_b32 v84 offset:41184
    v_cvt_pk_bf16_f32 v85, v104, v105
    ds_write_addtid_b32 v85 offset:17952
    v_pk_mul_f32 v[72:73], v[88:89], v[44:45] op_sel:[0,0] op_sel_hi:[1,0]
    v_pk_mul_f32 v[76:77], v[104:105], v[48:49] op_sel:[0,0] op_sel_hi:[1,0]
    v_pk_fma_f32 v[88:89], v[88:89], v[44:45], v[72:73] op_sel:[1,1,0] op_sel_hi:[0,1,1] neg_lo:[1,0,0]
    v_pk_fma_f32 v[104:105], v[104:105], v[48:49], v[76:77] op_sel:[1,1,0] op_sel_hi:[0,1,1] neg_hi:[1,0,0]
    v_cvt_pk_bf16_f32 v80, v88, v89
    ds_write_addtid_b32 v80 offset:42240
    v_cvt_pk_bf16_f32 v81, v104, v105
    ds_write_addtid_b32 v81 offset:19008
    v_pk_mul_f32 v[72:73], v[88:89], v[44:45] op_sel:[0,0] op_sel_hi:[1,0]
    v_pk_mul_f32 v[76:77], v[104:105], v[48:49] op_sel:[0,0] op_sel_hi:[1,0]
    v_pk_fma_f32 v[88:89], v[88:89], v[44:45], v[72:73] op_sel:[1,1,0] op_sel_hi:[0,1,1] neg_lo:[1,0,0]
    v_pk_fma_f32 v[104:105], v[104:105], v[48:49], v[76:77] op_sel:[1,1,0] op_sel_hi:[0,1,1] neg_hi:[1,0,0]
    v_cvt_pk_bf16_f32 v82, v88, v89
    ds_write_addtid_b32 v82 offset:43296
    v_cvt_pk_bf16_f32 v83, v104, v105
    ds_write_addtid_b32 v83 offset:20064
    v_pk_mul_f32 v[72:73], v[88:89], v[44:45] op_sel:[0,0] op_sel_hi:[1,0]
    v_pk_mul_f32 v[76:77], v[104:105], v[48:49] op_sel:[0,0] op_sel_hi:[1,0]
    v_pk_fma_f32 v[88:89], v[88:89], v[44:45], v[72:73] op_sel:[1,1,0] op_sel_hi:[0,1,1] neg_lo:[1,0,0]
    v_pk_fma_f32 v[104:105], v[104:105], v[48:49], v[76:77] op_sel:[1,1,0] op_sel_hi:[0,1,1] neg_hi:[1,0,0]
    v_cvt_pk_bf16_f32 v84, v88, v89
    ds_write_addtid_b32 v84 offset:44352
    v_cvt_pk_bf16_f32 v85, v104, v105
    ds_write_addtid_b32 v85 offset:21120
    v_pk_mul_f32 v[72:73], v[88:89], v[44:45] op_sel:[0,0] op_sel_hi:[1,0]
    v_pk_fma_f32 v[88:89], v[88:89], v[44:45], v[72:73] op_sel:[1,1,0] op_sel_hi:[0,1,1] neg_lo:[1,0,0]
    v_cvt_pk_bf16_f32 v80, v88, v89
    ds_write_addtid_b32 v80 offset:45408
    v_pk_mul_f32 v[72:73], v[88:89], v[44:45] op_sel:[0,0] op_sel_hi:[1,0]
    v_pk_fma_f32 v[88:89], v[88:89], v[44:45], v[72:73] op_sel:[1,1,0] op_sel_hi:[0,1,1] neg_lo:[1,0,0]
    v_cvt_pk_bf16_f32 v81, v88, v89
    ds_write_addtid_b32 v81 offset:46464
    v_pk_mul_f32 v[72:73], v[88:89], v[44:45] op_sel:[0,0] op_sel_hi:[1,0]
    v_pk_fma_f32 v[88:89], v[88:89], v[44:45], v[72:73] op_sel:[1,1,0] op_sel_hi:[0,1,1] neg_lo:[1,0,0]
    v_cvt_pk_bf16_f32 v82, v88, v89
    ds_write_addtid_b32 v82 offset:47520
    v_pk_mul_f32 v[72:73], v[88:89], v[44:45] op_sel:[0,0] op_sel_hi:[1,0]
    v_pk_fma_f32 v[88:89], v[88:89], v[44:45], v[72:73] op_sel:[1,1,0] op_sel_hi:[0,1,1] neg_lo:[1,0,0]
    v_cvt_pk_bf16_f32 v83, v88, v89
    ds_write_addtid_b32 v83 offset:48576
    v_pk_mul_f32 v[72:73], v[88:89], v[44:45] op_sel:[0,0] op_sel_hi:[1,0]
    v_pk_fma_f32 v[88:89], v[88:89], v[44:45], v[72:73] op_sel:[1,1,0] op_sel_hi:[0,1,1] neg_lo:[1,0,0]
    v_cvt_pk_bf16_f32 v84, v88, v89
    ds_write_addtid_b32 v84 offset:49632
    v_pk_mul_f32 v[72:73], v[88:89], v[44:45] op_sel:[0,0] op_sel_hi:[1,0]
    v_pk_fma_f32 v[88:89], v[88:89], v[44:45], v[72:73] op_sel:[1,1,0] op_sel_hi:[0,1,1] neg_lo:[1,0,0]
    v_cvt_pk_bf16_f32 v85, v88, v89
    ds_write_addtid_b32 v85 offset:50688
    v_pk_mul_f32 v[72:73], v[88:89], v[44:45] op_sel:[0,0] op_sel_hi:[1,0]
    v_pk_fma_f32 v[88:89], v[88:89], v[44:45], v[72:73] op_sel:[1,1,0] op_sel_hi:[0,1,1] neg_lo:[1,0,0]
    v_cvt_pk_bf16_f32 v80, v88, v89
    ds_write_addtid_b32 v80 offset:51744
    v_pk_mul_f32 v[72:73], v[88:89], v[44:45] op_sel:[0,0] op_sel_hi:[1,0]
    v_pk_fma_f32 v[88:89], v[88:89], v[44:45], v[72:73] op_sel:[1,1,0] op_sel_hi:[0,1,1] neg_lo:[1,0,0]
    v_cvt_pk_bf16_f32 v81, v88, v89
    ds_write_addtid_b32 v81 offset:52800
    v_pk_mul_f32 v[72:73], v[88:89], v[44:45] op_sel:[0,0] op_sel_hi:[1,0]
    v_pk_fma_f32 v[88:89], v[88:89], v[44:45], v[72:73] op_sel:[1,1,0] op_sel_hi:[0,1,1] neg_lo:[1,0,0]
    v_cvt_pk_bf16_f32 v82, v88, v89
    ds_write_addtid_b32 v82 offset:53856
    v_pk_mul_f32 v[72:73], v[88:89], v[44:45] op_sel:[0,0] op_sel_hi:[1,0]
    v_pk_fma_f32 v[88:89], v[88:89], v[44:45], v[72:73] op_sel:[1,1,0] op_sel_hi:[0,1,1] neg_lo:[1,0,0]
    v_cvt_pk_bf16_f32 v83, v88, v89
    ds_write_addtid_b32 v83 offset:54912
    s_waitcnt lgkmcnt(0)
    s_barrier
    v_and_b32 v3, 255, v0
    v_lshlrev_b32 v3, 6, v3
    v_add_u32 v3, 98304, v3
    buffer_load_dword v223, v3, s[56:59], 0 offen sc1
    v_mov_b32 v16, 0
    v_mov_b32 v17, 0
    v_mov_b32 v18, 0
    v_mov_b32 v19, 0
    ds_read_b128 v[32:35], v248 offset:0
    ds_read_b128 v[36:39], v249 offset:0
    ds_read_b128 v[40:43], v248 offset:64
    ds_read_b128 v[44:47], v249 offset:64
    ds_read_b128 v[48:51], v248 offset:128
    ds_read_b128 v[52:55], v249 offset:128
    ds_read_b128 v[56:59], v248 offset:192
    ds_read_b128 v[60:63], v249 offset:192
    ds_read_b128 v[64:67], v248 offset:256
    ds_read_b128 v[68:71], v249 offset:256
    ds_read_b128 v[72:75], v248 offset:320
    ds_read_b128 v[76:79], v249 offset:320
    s_waitcnt lgkmcnt(10)
    v_mfma_f32_16x16x32_bf16 v[16:19], v[32:35], v[36:39], v[16:19]
    ds_read_b128 v[32:35], v248 offset:384
    ds_read_b128 v[36:39], v249 offset:384
    s_waitcnt lgkmcnt(10)
    v_mfma_f32_16x16x32_bf16 v[16:19], v[40:43], v[44:47], v[16:19]
    ds_read_b128 v[40:43], v248 offset:448
    ds_read_b128 v[44:47], v249 offset:448
    s_waitcnt lgkmcnt(10)
    v_mfma_f32_16x16x32_bf16 v[16:19], v[48:51], v[52:55], v[16:19]
    ds_read_b128 v[48:51], v248 offset:512
    ds_read_b128 v[52:55], v249 offset:512
    s_waitcnt lgkmcnt(10)
    v_mfma_f32_16x16x32_bf16 v[16:19], v[56:59], v[60:63], v[16:19]
    ds_read_b128 v[56:59], v248 offset:576
    ds_read_b128 v[60:63], v249 offset:576
    s_waitcnt lgkmcnt(10)
    v_mfma_f32_16x16x32_bf16 v[16:19], v[64:67], v[68:71], v[16:19]
    ds_read_b128 v[64:67], v248 offset:640
    ds_read_b128 v[68:71], v249 offset:640
    s_waitcnt lgkmcnt(10)
    v_mfma_f32_16x16x32_bf16 v[16:19], v[72:75], v[76:79], v[16:19]
    ds_read_b128 v[72:75], v248 offset:704
    ds_read_b128 v[76:79], v249 offset:704
    s_waitcnt lgkmcnt(10)
    v_mfma_f32_16x16x32_bf16 v[16:19], v[32:35], v[36:39], v[16:19]
    ds_read_b128 v[32:35], v248 offset:768
    ds_read_b128 v[36:39], v249 offset:768
    s_waitcnt lgkmcnt(10)
    v_mfma_f32_16x16x32_bf16 v[16:19], v[40:43], v[44:47], v[16:19]
    ds_read_b128 v[40:43], v248 offset:832
    ds_read_b128 v[44:47], v249 offset:832
    s_waitcnt lgkmcnt(10)
    v_mfma_f32_16x16x32_bf16 v[16:19], v[48:51], v[52:55], v[16:19]
    ds_read_b128 v[48:51], v248 offset:896
    ds_read_b128 v[52:55], v249 offset:896
    s_waitcnt lgkmcnt(10)
    v_mfma_f32_16x16x32_bf16 v[16:19], v[56:59], v[60:63], v[16:19]
    s_mov_b32 s66, 0
L_s1_chk:
    s_waitcnt vmcnt(0)
    v_cmp_ne_u32 vcc, s33, v223
    s_cbranch_vccz L_s1_ok
    s_add_u32 s66, s66, 1
    s_cmp_gt_u32 s66, 30000
    s_cbranch_scc1 L_s1_ok
    buffer_load_dword v223, v3, s[56:59], 0 offen sc1
    s_branch L_s1_chk
L_s1_ok:
    v_and_b32 v8, 255, v0
    v_mul_u32_u24 v3, 7168, v8
    s_lshl_b32 s66, s70, 4
    s_add_u32 s66, s66, 2097152
    v_add_u32 v3, s66, v3
    buffer_load_dwordx4 v[200:203], v3, s[56:59], 0 offen
    s_cmp_lt_u32 s32, 4
    s_cbranch_scc0 L_s1_nost
    s_lshl_b32 s66, s32, 12
    v_lshl_add_u32 v3, v1, 4, s66
    s_add_u32 m0, s66, 142848
    s_nop 0
    buffer_load_dwordx4 v3, s[56:59], 0 offen offset:0 lds
    s_add_u32 m0, s66, 142848
    s_nop 0
    buffer_load_dwordx4 v3, s[56:59], 0 offen offset:1024 lds
    s_add_u32 m0, s66, 142848
    s_nop 0
    buffer_load_dwordx4 v3, s[56:59], 0 offen offset:2048 lds
    s_add_u32 m0, s66, 142848
    s_nop 0
    buffer_load_dwordx4 v3, s[56:59], 0 offen offset:3072 lds
L_s1_nost:
    ds_read_b128 v[56:59], v248 offset:960
    ds_read_b128 v[60:63], v249 offset:960
    s_waitcnt lgkmcnt(10)
    v_mfma_f32_16x16x32_bf16 v[16:19], v[64:67], v[68:71], v[16:19]
    s_waitcnt lgkmcnt(8)
    v_mfma_f32_16x16x32_bf16 v[16:19], v[72:75], v[76:79], v[16:19]
    s_waitcnt lgkmcnt(6)
    v_mfma_f32_16x16x32_bf16 v[16:19], v[32:35], v[36:39], v[16:19]
    s_waitcnt lgkmcnt(4)
    v_mfma_f32_16x16x32_bf16 v[16:19], v[40:43], v[44:47], v[16:19]
    s_waitcnt lgkmcnt(2)
    v_mfma_f32_16x16x32_bf16 v[16:19], v[48:51], v[52:55], v[16:19]
    s_waitcnt lgkmcnt(0)
    v_mfma_f32_16x16x32_bf16 v[16:19], v[56:59], v[60:63], v[16:19]
    s_nop 7
    v_cvt_pk_bf16_f32 v16, v16, v17
    v_cvt_pk_bf16_f32 v17, v18, v19
    s_cmp_eq_u32 s74, 0
    s_cbranch_scc0 L_tw_rt1
    ds_write_b32 v238, v16
    ds_write_b32 v239, v17
    s_branch L_tw_done
L_tw_rt1:
    ds_write_b16 v238, v16
    ds_write_b16_d16_hi v239, v16
    ds_write_b16 v240, v17
    ds_write_b16_d16_hi v241, v17
L_tw_done:
    s_waitcnt lgkmcnt(0)
    s_barrier
    s_and_b32 s64, s2, 7
    s_lshr_b32 s65, s2, 3
    s_lshr_b32 s41, s64, 1
    s_lshl_b32 s41, s41, 2
    s_and_b32 s66, s65, 3
    s_add_u32 s41, s41, s66
    s_and_b32 s40, s64, 1
    s_mul_i32 s40, s40, 7
    s_lshr_b32 s66, s65, 2
    s_add_u32 s40, s40, s66
    s_and_b32 s64, s65, 3
    s_mul_i32 s64, s64, 3
    s_lshr_b32 s66, s65, 2
    s_lshl_b32 s66, s66, 1
    s_add_u32 s64, s64, s66
    s_sub_u32 s66, s64, 14
    s_cmp_ge_u32 s64, 14
    s_cselect_b32 s64, s66, s64
    s_sub_u32 s66, s64, 14
    s_cmp_ge_u32 s64, 14
    s_cselect_b32 s64, s66, s64
    s_lshl_b32 s51, s64, 1
    s_lshr_b32 s42, s32, 2
    s_lshl_b32 s43, s32, 10
    s_cmp_eq_u32 s42, 0
    s_cselect_b32 s52, s20, s22
    s_cselect_b32 s53, s21, s23
    s_mov_b32 s54, 1605632
    s_mov_b32 s55, 0x20000
    v_lshrrev_b32 v2, 4, v1
    v_and_b32 v3, 15, v1
    v_lshlrev_b32 v250, 1, v2
    v_add_u32 v250, s42, v250
    v_lshlrev_b32 v250, 1, v250
    v_xor_b32 v250, v250, v3
    v_lshlrev_b32 v250, 4, v250
    s_and_b32 s64, s32, 3
    s_lshl_b32 s64, s64, 2
    v_add_u32 v2, s64, v2
    s_movk_i32 s65, 3584
    v_mul_lo_u32 v2, v2, s65
    v_add_u32 v250, v250, v2
    s_lshl_b32 s65, s40, 8
    v_add_u32 v250, s65, v250
    ds_read_u16 v70, v226
    ds_read_u16 v71, v227
    ds_read_u16 v72, v228
    ds_read_u16 v73, v229
    ds_read_u16 v74, v230
    ds_read_u16 v75, v231
    ds_read_u16 v76, v232
    ds_read_u16 v77, v233
    ds_read_u16 v78, v234
    ds_read_u16 v79, v235
    ds_read_u16 v80, v236
    v_mov_b32 v20, 0
    v_mov_b32 v21, 0
    v_mov_b32 v22, 0
    v_mov_b32 v23, 0
    v_lshrrev_b32 v16, 1, v0
    s_movk_i32 s65, 4160
    v_mul_lo_u32 v16, v16, s65
    v_and_b32 v17, 1, v0
    v_lshl_add_u32 v16, v17, 4, v16
    s_waitcnt lgkmcnt(0)
    v_lshl_or_b32 v110, v71, 16, v70
    v_lshl_or_b32 v111, v73, 16, v72
    v_lshl_or_b32 v112, v75, 16, v74
    v_lshl_or_b32 v113, v77, 16, v76
    ds_write_b128 v237, v[110:113] offset:0
    v_lshl_or_b32 v114, v72, 16, v71
    v_lshl_or_b32 v115, v74, 16, v73
    v_lshl_or_b32 v116, v76, 16, v75
    v_lshl_or_b32 v117, v78, 16, v77
    ds_write_b128 v237, v[114:117] offset:4160
    v_lshl_or_b32 v118, v73, 16, v72
    v_lshl_or_b32 v119, v75, 16, v74
    v_lshl_or_b32 v120, v77, 16, v76
    v_lshl_or_b32 v121, v79, 16, v78
    ds_write_b128 v237, v[118:121] offset:8320
    v_lshl_or_b32 v122, v74, 16, v73
    v_lshl_or_b32 v123, v76, 16, v75
    v_lshl_or_b32 v124, v78, 16, v77
    v_lshl_or_b32 v125, v80, 16, v79
    ds_write_b128 v237, v[122:125] offset:12480
    v_cmp_gt_u32 vcc, 16, v0
    s_nop 3
    s_and_saveexec_b64 s[66:67], vcc
    ds_write_b128 v16, v[20:23] offset:4128
    s_mov_b64 exec, s[66:67]
    s_lshl_b32 s65, s34, 4
    s_lshr_b32 s64, s69, s65
    s_lshl_b32 s64, s64, 16
    s_waitcnt vmcnt(0)
    s_barrier
    v_and_b32 v8, 255, v0
    v_lshlrev_b32 v9, 6, v8
    v_add_u32 v9, 142848, v9
    ds_read_b128 v[204:207], v9 offset:0
    ds_read_b128 v[208:211], v9 offset:16
    ds_read_b128 v[212:215], v9 offset:32
    ds_read_b128 v[216:219], v9 offset:48
    s_waitcnt lgkmcnt(0)
    v_lshlrev_b32 v30, 16, v200
    v_fma_f32 v40, v30, v204, v205
    v_fma_f32 v48, v40, s64, v30
    v_and_b32 v31, 0xffff0000, v200
    v_fma_f32 v41, v31, v206, v207
    v_fma_f32 v49, v41, s64, v31
    v_lshlrev_b32 v32, 16, v201
    v_fma_f32 v42, v32, v208, v209
    v_fma_f32 v50, v42, s64, v32
    v_and_b32 v33, 0xffff0000, v201
    v_fma_f32 v43, v33, v210, v211
    v_fma_f32 v51, v43, s64, v33
    v_lshlrev_b32 v34, 16, v202
    v_fma_f32 v44, v34, v212, v213
    v_fma_f32 v52, v44, s64, v34
    v_and_b32 v35, 0xffff0000, v202
    v_fma_f32 v45, v35, v214, v215
    v_fma_f32 v53, v45, s64, v35
    v_lshlrev_b32 v36, 16, v203
    v_fma_f32 v46, v36, v216, v217
    v_fma_f32 v54, v46, s64, v36
    v_and_b32 v37, 0xffff0000, v203
    v_fma_f32 v47, v37, v218, v219
    v_fma_f32 v55, v47, s64, v37
    v_cvt_pk_bf16_f32 v56, v40, v41
    v_cvt_pk_bf16_f32 v57, v42, v43
    v_cvt_pk_bf16_f32 v58, v44, v45
    v_cvt_pk_bf16_f32 v59, v46, v47
    v_and_b32 v8, 255, v0
    s_mul_i32 s66, s34, 4576
    s_add_u32 s66, s66, 117792
    v_lshl_add_u32 v9, v8, 4, s66
    ds_write_b128 v9, v[56:59]
    s_mul_i32 s66, s34, 8192
    s_add_u32 s66, s66, 126464
    v_lshl_add_u32 v9, v8, 5, s66
    ds_write_b128 v9, v[48:51]
    ds_write_b128 v9, v[52:55] offset:16
    s_waitcnt vmcnt(0) lgkmcnt(0)
    s_barrier
    s_cmp_eq_u32 s35, 0
    s_cbranch_scc1 L_conv0
    s_cmp_eq_u32 s35, 1
    s_cbranch_scc1 L_conv1
    s_cmp_eq_u32 s35, 2
    s_cbranch_scc1 L_conv2
    s_branch L_conv3
L_conv0:
    v_lshlrev_b32 v2, 4, v1
    s_lshl_b32 s64, s34, 2
    s_add_u32 s64, s64, 1
    s_mul_i32 s64, s64, 6144
    s_add_u32 s64, s64, 114688
    v_add_u32 v5, s64, v2
    s_lshl_b32 s64, s34, 2
    s_add_u32 s64, s64, 2
    s_mul_i32 s64, s64, 6144
    s_add_u32 s64, s64, 114688
    v_add_u32 v6, s64, v2
    s_lshl_b32 s64, s34, 2
    s_add_u32 s64, s64, 3
    s_mul_i32 s64, s64, 6144
    s_add_u32 s64, s64, 114688
    v_add_u32 v7, s64, v2
    ds_read_b64 v[112:113], v244 offset:4032
    ds_read_b64 v[114:115], v244 offset:4040
    ds_read_b128 v[48:51], v245 offset:4032
    ds_read_b128 v[56:59], v245 offset:3520
    ds_read_b128 v[64:67], v245 offset:3008
    ds_read_b128 v[72:75], v245 offset:2496
    ds_read_b128 v[80:83], v245 offset:1984
    ds_read_b128 v[88:91], v245 offset:1472
    ds_read_b128 v[96:99], v245 offset:960
    ds_read_b128 v[104:107], v245 offset:448
    ds_read_b64 v[116:117], v244 offset:3776
    ds_read_b64 v[118:119], v244 offset:3784
    ds_read_b128 v[16:19], v246 offset:0
    ds_read_b128 v[20:23], v246 offset:1024
    ds_read_b128 v[24:27], v246 offset:2048
    ds_read_b128 v[28:31], v246 offset:3072
    ds_read_b128 v[32:35], v246 offset:4096
    ds_read_b128 v[36:39], v246 offset:5120
    ds_read_b128 v[40:43], v246 offset:6144
    ds_read_b128 v[44:47], v246 offset:7168
    ds_read_b128 v[52:55], v245 offset:3776
    ds_read_b128 v[60:63], v245 offset:3264
    ds_read_b128 v[68:71], v245 offset:2752
    ds_read_b128 v[76:79], v245 offset:2240
    ds_read_b128 v[84:87], v245 offset:1728
    ds_read_b128 v[92:95], v245 offset:1216
    ds_read_b128 v[100:103], v245 offset:704
    ds_read_b128 v[108:111], v245 offset:192
    ds_read_b64 v[120:121], v244 offset:3520
    ds_read_b64 v[122:123], v244 offset:3528
    ds_read_b64 v[124:125], v244 offset:3264
    ds_read_b64 v[126:127], v244 offset:3272
    s_waitcnt lgkmcnt(12)
    v_mfma_f32_16x16x32_bf16 v[44:47], v[112:115], v[48:51], v[44:47]
    v_mfma_f32_16x16x32_bf16 v[40:43], v[112:115], v[56:59], v[40:43]
    v_mfma_f32_16x16x32_bf16 v[36:39], v[112:115], v[64:67], v[36:39]
    v_mfma_f32_16x16x32_bf16 v[32:35], v[112:115], v[72:75], v[32:35]
    v_mfma_f32_16x16x32_bf16 v[28:31], v[112:115], v[80:83], v[28:31]
    v_mfma_f32_16x16x32_bf16 v[24:27], v[112:115], v[88:91], v[24:27]
    v_mfma_f32_16x16x32_bf16 v[20:23], v[112:115], v[96:99], v[20:23]
    v_mfma_f32_16x16x32_bf16 v[16:19], v[112:115], v[104:107], v[16:19]
    ds_read_b64 v[112:113], v244 offset:3008
    ds_read_b64 v[114:115], v244 offset:3016
    s_waitcnt lgkmcnt(6)
    s_barrier
    v_mfma_f32_16x16x32_bf16 v[44:47], v[116:119], v[52:55], v[44:47]
    v_mfma_f32_16x16x32_bf16 v[40:43], v[116:119], v[60:63], v[40:43]
    v_mfma_f32_16x16x32_bf16 v[36:39], v[116:119], v[68:71], v[36:39]
    v_mfma_f32_16x16x32_bf16 v[32:35], v[116:119], v[76:79], v[32:35]
    v_mfma_f32_16x16x32_bf16 v[28:31], v[116:119], v[84:87], v[28:31]
    v_mfma_f32_16x16x32_bf16 v[24:27], v[116:119], v[92:95], v[24:27]
    v_mfma_f32_16x16x32_bf16 v[20:23], v[116:119], v[100:103], v[20:23]
    v_mfma_f32_16x16x32_bf16 v[16:19], v[116:119], v[108:111], v[16:19]
    s_add_u32 m0, s43, 40960
    s_mov_b32 s67, 0
    buffer_load_dwordx4 v250, s[52:55], s67 offen lds
    ds_read_b64 v[116:117], v244 offset:2752
    ds_read_b64 v[118:119], v244 offset:2760
    s_waitcnt lgkmcnt(6)
    v_mfma_f32_16x16x32_bf16 v[44:47], v[120:123], v[56:59], v[44:47]
    v_mfma_f32_16x16x32_bf16 v[40:43], v[120:123], v[64:67], v[40:43]
    v_mfma_f32_16x16x32_bf16 v[36:39], v[120:123], v[72:75], v[36:39]
    v_mfma_f32_16x16x32_bf16 v[32:35], v[120:123], v[80:83], v[32:35]
    v_mfma_f32_16x16x32_bf16 v[28:31], v[120:123], v[88:91], v[28:31]
    v_mfma_f32_16x16x32_bf16 v[24:27], v[120:123], v[96:99], v[24:27]
    v_mfma_f32_16x16x32_bf16 v[20:23], v[120:123], v[104:107], v[20:23]
    s_add_u32 m0, s43, 49152
    s_mov_b32 s67, 57344
    buffer_load_dwordx4 v250, s[52:55], s67 offen lds
    ds_read_b64 v[120:121], v244 offset:2496
    ds_read_b64 v[122:123], v244 offset:2504
    s_waitcnt lgkmcnt(6)
    v_mfma_f32_16x16x32_bf16 v[44:47], v[124:127], v[60:63], v[44:47]
    v_mfma_f32_16x16x32_bf16 v[40:43], v[124:127], v[68:71], v[40:43]
    v_mfma_f32_16x16x32_bf16 v[36:39], v[124:127], v[76:79], v[36:39]
    v_mfma_f32_16x16x32_bf16 v[32:35], v[124:127], v[84:87], v[32:35]
    v_mfma_f32_16x16x32_bf16 v[28:31], v[124:127], v[92:95], v[28:31]
    v_mfma_f32_16x16x32_bf16 v[24:27], v[124:127], v[100:103], v[24:27]
    v_mfma_f32_16x16x32_bf16 v[20:23], v[124:127], v[108:111], v[20:23]
    s_add_u32 m0, s43, 57344
    s_mov_b32 s67, 114688
    buffer_load_dwordx4 v250, s[52:55], s67 offen lds
    ds_read_b64 v[124:125], v244 offset:2240
    ds_read_b64 v[126:127], v244 offset:2248
    s_waitcnt lgkmcnt(6)
    v_mfma_f32_16x16x32_bf16 v[44:47], v[112:115], v[64:67], v[44:47]
    v_mfma_f32_16x16x32_bf16 v[40:43], v[112:115], v[72:75], v[40:43]
    v_mfma_f32_16x16x32_bf16 v[36:39], v[112:115], v[80:83], v[36:39]
    v_mfma_f32_16x16x32_bf16 v[32:35], v[112:115], v[88:91], v[32:35]
    v_mfma_f32_16x16x32_bf16 v[28:31], v[112:115], v[96:99], v[28:31]
    v_mfma_f32_16x16x32_bf16 v[24:27], v[112:115], v[104:107], v[24:27]
    s_add_u32 m0, s43, 65536
    s_mov_b32 s67, 172032
    buffer_load_dwordx4 v250, s[52:55], s67 offen lds
    ds_read_b64 v[112:113], v244 offset:1984
    ds_read_b64 v[114:115], v244 offset:1992
    s_waitcnt lgkmcnt(6)
    v_mfma_f32_16x16x32_bf16 v[44:47], v[116:119], v[68:71], v[44:47]
    v_mfma_f32_16x16x32_bf16 v[40:43], v[116:119], v[76:79], v[40:43]
    v_mfma_f32_16x16x32_bf16 v[36:39], v[116:119], v[84:87], v[36:39]
    v_mfma_f32_16x16x32_bf16 v[32:35], v[116:119], v[92:95], v[32:35]
    v_mfma_f32_16x16x32_bf16 v[28:31], v[116:119], v[100:103], v[28:31]
    v_mfma_f32_16x16x32_bf16 v[24:27], v[116:119], v[108:111], v[24:27]
    s_add_u32 m0, s43, 73728
    s_mov_b32 s67, 229376
    buffer_load_dwordx4 v250, s[52:55], s67 offen lds
    ds_read_b64 v[116:117], v244 offset:1728
    ds_read_b64 v[118:119], v244 offset:1736
    s_waitcnt lgkmcnt(6)
    v_mfma_f32_16x16x32_bf16 v[44:47], v[120:123], v[72:75], v[44:47]
    v_mfma_f32_16x16x32_bf16 v[40:43], v[120:123], v[80:83], v[40:43]
    v_mfma_f32_16x16x32_bf16 v[36:39], v[120:123], v[88:91], v[36:39]
    v_mfma_f32_16x16x32_bf16 v[32:35], v[120:123], v[96:99], v[32:35]
    v_mfma_f32_16x16x32_bf16 v[28:31], v[120:123], v[104:107], v[28:31]
    s_add_u32 m0, s43, 81920
    s_mov_b32 s67, 286720
    buffer_load_dwordx4 v250, s[52:55], s67 offen lds
    ds_read_b64 v[120:121], v244 offset:1472
    ds_read_b64 v[122:123], v244 offset:1480
    s_waitcnt lgkmcnt(6)
    v_mfma_f32_16x16x32_bf16 v[44:47], v[124:127], v[76:79], v[44:47]
    v_mfma_f32_16x16x32_bf16 v[40:43], v[124:127], v[84:87], v[40:43]
    v_mfma_f32_16x16x32_bf16 v[36:39], v[124:127], v[92:95], v[36:39]
    v_mfma_f32_16x16x32_bf16 v[32:35], v[124:127], v[100:103], v[32:35]
    v_mfma_f32_16x16x32_bf16 v[28:31], v[124:127], v[108:111], v[28:31]
    s_add_u32 m0, s43, 90112
    s_mov_b32 s67, 344064
    buffer_load_dwordx4 v250, s[52:55], s67 offen lds
    ds_read_b64 v[124:125], v244 offset:1216
    ds_read_b64 v[126:127], v244 offset:1224
    s_waitcnt lgkmcnt(6)
    v_mfma_f32_16x16x32_bf16 v[44:47], v[112:115], v[80:83], v[44:47]
    v_mfma_f32_16x16x32_bf16 v[40:43], v[112:115], v[88:91], v[40:43]
    v_mfma_f32_16x16x32_bf16 v[36:39], v[112:115], v[96:99], v[36:39]
    v_mfma_f32_16x16x32_bf16 v[32:35], v[112:115], v[104:107], v[32:35]
    s_add_u32 m0, s43, 98304
    s_mov_b32 s67, 401408
    buffer_load_dwordx4 v250, s[52:55], s67 offen lds
    ds_read_b64 v[112:113], v244 offset:960
    ds_read_b64 v[114:115], v244 offset:968
    s_waitcnt lgkmcnt(6)
    v_mfma_f32_16x16x32_bf16 v[44:47], v[116:119], v[84:87], v[44:47]
    v_mfma_f32_16x16x32_bf16 v[40:43], v[116:119], v[92:95], v[40:43]
    v_mfma_f32_16x16x32_bf16 v[36:39], v[116:119], v[100:103], v[36:39]
    v_mfma_f32_16x16x32_bf16 v[32:35], v[116:119], v[108:111], v[32:35]
    ds_write_b128 v5, v[24:27]
    ds_write_b128 v5, v[28:31] offset:1024
    s_add_u32 m0, s43, 106496
    s_mov_b32 s67, 458752
    buffer_load_dwordx4 v250, s[52:55], s67 offen lds
    ds_read_b64 v[116:117], v244 offset:704
    ds_read_b64 v[118:119], v244 offset:712
    s_waitcnt lgkmcnt(8)
    v_mfma_f32_16x16x32_bf16 v[44:47], v[120:123], v[88:91], v[44:47]
    v_mfma_f32_16x16x32_bf16 v[40:43], v[120:123], v[96:99], v[40:43]
    v_mfma_f32_16x16x32_bf16 v[36:39], v[120:123], v[104:107], v[36:39]
    ds_read_b64 v[120:121], v244 offset:448
    ds_read_b64 v[122:123], v244 offset:456
    s_waitcnt lgkmcnt(8)
    v_mfma_f32_16x16x32_bf16 v[44:47], v[124:127], v[92:95], v[44:47]
    v_mfma_f32_16x16x32_bf16 v[40:43], v[124:127], v[100:103], v[40:43]
    v_mfma_f32_16x16x32_bf16 v[36:39], v[124:127], v[108:111], v[36:39]
    ds_read_b64 v[124:125], v244 offset:192
    ds_read_b64 v[126:127], v244 offset:200
    s_waitcnt lgkmcnt(8)
    v_mfma_f32_16x16x32_bf16 v[44:47], v[112:115], v[96:99], v[44:47]
    v_mfma_f32_16x16x32_bf16 v[40:43], v[112:115], v[104:107], v[40:43]
    s_waitcnt lgkmcnt(4)
    v_mfma_f32_16x16x32_bf16 v[44:47], v[116:119], v[100:103], v[44:47]
    v_mfma_f32_16x16x32_bf16 v[40:43], v[116:119], v[108:111], v[40:43]
    ds_write_b128 v6, v[32:35]
    ds_write_b128 v6, v[36:39] offset:1024
    s_waitcnt lgkmcnt(4)
    v_mfma_f32_16x16x32_bf16 v[44:47], v[120:123], v[104:107], v[44:47]
    s_waitcnt lgkmcnt(2)
    v_mfma_f32_16x16x32_bf16 v[44:47], v[124:127], v[108:111], v[44:47]
    s_nop 1
    ds_write_b128 v7, v[40:43]
    s_nop 4
    ds_write_b128 v7, v[44:47] offset:1024
    s_mul_i32 s64, s32, 6144
    s_add_u32 s64, s64, 114688
    v_add_u32 v3, s64, v2
    s_waitcnt lgkmcnt(0)
    s_barrier
    ds_read_b128 v[48:51], v3 offset:0
    ds_read_b128 v[52:55], v3 offset:1024
    ds_read_b128 v[56:59], v3 offset:2048
    ds_read_b128 v[60:63], v3 offset:3072
    ds_read_b128 v[64:67], v3 offset:4096
    ds_read_b128 v[68:71], v3 offset:5120
    s_waitcnt lgkmcnt(0)
    v_add_f32 v16, v16, v48
    v_add_f32 v17, v17, v49
    v_add_f32 v18, v18, v50
    v_add_f32 v19, v19, v51
    v_add_f32 v20, v20, v52
    v_add_f32 v21, v21, v53
    v_add_f32 v22, v22, v54
    v_add_f32 v23, v23, v55
    v_add_f32 v16, v16, v56
    v_add_f32 v17, v17, v57
    v_add_f32 v18, v18, v58
    v_add_f32 v19, v19, v59
    v_add_f32 v20, v20, v60
    v_add_f32 v21, v21, v61
    v_add_f32 v22, v22, v62
    v_add_f32 v23, v23, v63
    v_add_f32 v16, v16, v64
    v_add_f32 v17, v17, v65
    v_add_f32 v18, v18, v66
    v_add_f32 v19, v19, v67
    v_add_f32 v20, v20, v68
    v_add_f32 v21, v21, v69
    v_add_f32 v22, v22, v70
    v_add_f32 v23, v23, v71
    v_cvt_pk_bf16_f32 v80, v16, v17
    v_cvt_pk_bf16_f32 v81, v18, v19
    buffer_store_dwordx2 v[80:81], v247, s[56:59], 0 offen offset:0 sc1
    v_cvt_pk_bf16_f32 v82, v20, v21
    v_cvt_pk_bf16_f32 v83, v22, v23
    buffer_store_dwordx2 v[82:83], v247, s[56:59], 0 offen offset:512 sc1
    s_branch L_conv_done
L_conv1:
    v_lshlrev_b32 v2, 4, v1
    s_lshl_b32 s64, s34, 2
    s_add_u32 s64, s64, 0
    s_mul_i32 s64, s64, 6144
    s_add_u32 s64, s64, 114688
    v_add_u32 v4, s64, v2
    s_lshl_b32 s64, s34, 2
    s_add_u32 s64, s64, 2
    s_mul_i32 s64, s64, 6144
    s_add_u32 s64, s64, 116736
    v_add_u32 v6, s64, v2
    s_lshl_b32 s64, s34, 2
    s_add_u32 s64, s64, 3
    s_mul_i32 s64, s64, 6144
    s_add_u32 s64, s64, 116736
    v_add_u32 v7, s64, v2
    ds_read_b64 v[112:113], v244 offset:3968
    ds_read_b64 v[114:115], v244 offset:3976
    ds_read_b128 v[48:51], v245 offset:3968
    ds_read_b128 v[56:59], v245 offset:3456
    ds_read_b128 v[64:67], v245 offset:2944
    ds_read_b128 v[72:75], v245 offset:2432
    ds_read_b128 v[80:83], v245 offset:1920
    ds_read_b128 v[88:91], v245 offset:1408
    ds_read_b128 v[96:99], v245 offset:896
    ds_read_b128 v[104:107], v245 offset:384
    ds_read_b64 v[116:117], v244 offset:3712
    ds_read_b64 v[118:119], v244 offset:3720
    v_mov_b32 v16, 0
    v_mov_b32 v17, 0
    v_mov_b32 v18, 0
    v_mov_b32 v19, 0
    v_mov_b32 v20, 0
    v_mov_b32 v21, 0
    v_mov_b32 v22, 0
    v_mov_b32 v23, 0
    v_mov_b32 v24, 0
    v_mov_b32 v25, 0
    v_mov_b32 v26, 0
    v_mov_b32 v27, 0
    v_mov_b32 v28, 0
    v_mov_b32 v29, 0
    v_mov_b32 v30, 0
    v_mov_b32 v31, 0
    v_mov_b32 v32, 0
    v_mov_b32 v33, 0
    v_mov_b32 v34, 0
    v_mov_b32 v35, 0
    v_mov_b32 v36, 0
    v_mov_b32 v37, 0
    v_mov_b32 v38, 0
    v_mov_b32 v39, 0
    v_mov_b32 v40, 0
    v_mov_b32 v41, 0
    v_mov_b32 v42, 0
    v_mov_b32 v43, 0
    v_mov_b32 v44, 0
    v_mov_b32 v45, 0
    v_mov_b32 v46, 0
    v_mov_b32 v47, 0
    ds_read_b128 v[52:55], v245 offset:3712
    ds_read_b128 v[60:63], v245 offset:3200
    ds_read_b128 v[68:71], v245 offset:2688
    ds_read_b128 v[76:79], v245 offset:2176
    ds_read_b128 v[84:87], v245 offset:1664
    ds_read_b128 v[92:95], v245 offset:1152
    ds_read_b128 v[100:103], v245 offset:640
    ds_read_b128 v[108:111], v245 offset:128
    ds_read_b64 v[120:121], v244 offset:3456
    ds_read_b64 v[122:123], v244 offset:3464
    ds_read_b64 v[124:125], v244 offset:3200
    ds_read_b64 v[126:127], v244 offset:3208
    s_waitcnt lgkmcnt(14)
    v_mfma_f32_16x16x32_bf16 v[44:47], v[112:115], v[48:51], v[44:47]
    v_mfma_f32_16x16x32_bf16 v[40:43], v[112:115], v[56:59], v[40:43]
    v_mfma_f32_16x16x32_bf16 v[36:39], v[112:115], v[64:67], v[36:39]
    v_mfma_f32_16x16x32_bf16 v[32:35], v[112:115], v[72:75], v[32:35]
    v_mfma_f32_16x16x32_bf16 v[28:31], v[112:115], v[80:83], v[28:31]
    v_mfma_f32_16x16x32_bf16 v[24:27], v[112:115], v[88:91], v[24:27]
    v_mfma_f32_16x16x32_bf16 v[20:23], v[112:115], v[96:99], v[20:23]
    v_mfma_f32_16x16x32_bf16 v[16:19], v[112:115], v[104:107], v[16:19]
    ds_read_b64 v[112:113], v244 offset:2944
    ds_read_b64 v[114:115], v244 offset:2952
    s_waitcnt lgkmcnt(6)
    s_barrier
    v_mfma_f32_16x16x32_bf16 v[44:47], v[116:119], v[52:55], v[44:47]
    v_mfma_f32_16x16x32_bf16 v[40:43], v[116:119], v[60:63], v[40:43]
    v_mfma_f32_16x16x32_bf16 v[36:39], v[116:119], v[68:71], v[36:39]
    v_mfma_f32_16x16x32_bf16 v[32:35], v[116:119], v[76:79], v[32:35]
    v_mfma_f32_16x16x32_bf16 v[28:31], v[116:119], v[84:87], v[28:31]
    v_mfma_f32_16x16x32_bf16 v[24:27], v[116:119], v[92:95], v[24:27]
    v_mfma_f32_16x16x32_bf16 v[20:23], v[116:119], v[100:103], v[20:23]
    v_mfma_f32_16x16x32_bf16 v[16:19], v[116:119], v[108:111], v[16:19]
    ds_read_b64 v[116:117], v244 offset:2688
    ds_read_b64 v[118:119], v244 offset:2696
    s_waitcnt lgkmcnt(6)
    v_mfma_f32_16x16x32_bf16 v[44:47], v[120:123], v[56:59], v[44:47]
    v_mfma_f32_16x16x32_bf16 v[40:43], v[120:123], v[64:67], v[40:43]
    v_mfma_f32_16x16x32_bf16 v[36:39], v[120:123], v[72:75], v[36:39]
    v_mfma_f32_16x16x32_bf16 v[32:35], v[120:123], v[80:83], v[32:35]
    v_mfma_f32_16x16x32_bf16 v[28:31], v[120:123], v[88:91], v[28:31]
    v_mfma_f32_16x16x32_bf16 v[24:27], v[120:123], v[96:99], v[24:27]
    v_mfma_f32_16x16x32_bf16 v[20:23], v[120:123], v[104:107], v[20:23]
    ds_read_b64 v[120:121], v244 offset:2432
    ds_read_b64 v[122:123], v244 offset:2440
    s_waitcnt lgkmcnt(6)
    v_mfma_f32_16x16x32_bf16 v[44:47], v[124:127], v[60:63], v[44:47]
    v_mfma_f32_16x16x32_bf16 v[40:43], v[124:127], v[68:71], v[40:43]
    v_mfma_f32_16x16x32_bf16 v[36:39], v[124:127], v[76:79], v[36:39]
    v_mfma_f32_16x16x32_bf16 v[32:35], v[124:127], v[84:87], v[32:35]
    v_mfma_f32_16x16x32_bf16 v[28:31], v[124:127], v[92:95], v[28:31]
    v_mfma_f32_16x16x32_bf16 v[24:27], v[124:127], v[100:103], v[24:27]
    v_mfma_f32_16x16x32_bf16 v[20:23], v[124:127], v[108:111], v[20:23]
    s_add_u32 m0, s43, 40960
    s_mov_b32 s67, 0
    buffer_load_dwordx4 v250, s[52:55], s67 offen lds
    ds_read_b64 v[124:125], v244 offset:2176
    ds_read_b64 v[126:127], v244 offset:2184
    s_waitcnt lgkmcnt(6)
    v_mfma_f32_16x16x32_bf16 v[44:47], v[112:115], v[64:67], v[44:47]
    v_mfma_f32_16x16x32_bf16 v[40:43], v[112:115], v[72:75], v[40:43]
    v_mfma_f32_16x16x32_bf16 v[36:39], v[112:115], v[80:83], v[36:39]
    v_mfma_f32_16x16x32_bf16 v[32:35], v[112:115], v[88:91], v[32:35]
    v_mfma_f32_16x16x32_bf16 v[28:31], v[112:115], v[96:99], v[28:31]
    v_mfma_f32_16x16x32_bf16 v[24:27], v[112:115], v[104:107], v[24:27]
    s_add_u32 m0, s43, 49152
    s_mov_b32 s67, 57344
    buffer_load_dwordx4 v250, s[52:55], s67 offen lds
    ds_read_b64 v[112:113], v244 offset:1920
    ds_read_b64 v[114:115], v244 offset:1928
    s_waitcnt lgkmcnt(6)
    v_mfma_f32_16x16x32_bf16 v[44:47], v[116:119], v[68:71], v[44:47]
    v_mfma_f32_16x16x32_bf16 v[40:43], v[116:119], v[76:79], v[40:43]
    v_mfma_f32_16x16x32_bf16 v[36:39], v[116:119], v[84:87], v[36:39]
    v_mfma_f32_16x16x32_bf16 v[32:35], v[116:119], v[92:95], v[32:35]
    v_mfma_f32_16x16x32_bf16 v[28:31], v[116:119], v[100:103], v[28:31]
    v_mfma_f32_16x16x32_bf16 v[24:27], v[116:119], v[108:111], v[24:27]
    ds_write_b128 v4, v[16:19]
    ds_write_b128 v4, v[20:23] offset:1024
    s_add_u32 m0, s43, 57344
    s_mov_b32 s67, 114688
    buffer_load_dwordx4 v250, s[52:55], s67 offen lds
    ds_read_b64 v[116:117], v244 offset:1664
    ds_read_b64 v[118:119], v244 offset:1672
    s_waitcnt lgkmcnt(8)
    v_mfma_f32_16x16x32_bf16 v[44:47], v[120:123], v[72:75], v[44:47]
    v_mfma_f32_16x16x32_bf16 v[40:43], v[120:123], v[80:83], v[40:43]
    v_mfma_f32_16x16x32_bf16 v[36:39], v[120:123], v[88:91], v[36:39]
    v_mfma_f32_16x16x32_bf16 v[32:35], v[120:123], v[96:99], v[32:35]
    v_mfma_f32_16x16x32_bf16 v[28:31], v[120:123], v[104:107], v[28:31]
    s_add_u32 m0, s43, 65536
    s_mov_b32 s67, 172032
    buffer_load_dwordx4 v250, s[52:55], s67 offen lds
    ds_read_b64 v[120:121], v244 offset:1408
    ds_read_b64 v[122:123], v244 offset:1416
    s_waitcnt lgkmcnt(8)
    v_mfma_f32_16x16x32_bf16 v[44:47], v[124:127], v[76:79], v[44:47]
    v_mfma_f32_16x16x32_bf16 v[40:43], v[124:127], v[84:87], v[40:43]
    v_mfma_f32_16x16x32_bf16 v[36:39], v[124:127], v[92:95], v[36:39]
    v_mfma_f32_16x16x32_bf16 v[32:35], v[124:127], v[100:103], v[32:35]
    v_mfma_f32_16x16x32_bf16 v[28:31], v[124:127], v[108:111], v[28:31]
    s_add_u32 m0, s43, 73728
    s_mov_b32 s67, 229376
    buffer_load_dwordx4 v250, s[52:55], s67 offen lds
    ds_read_b64 v[124:125], v244 offset:1152
    ds_read_b64 v[126:127], v244 offset:1160
    s_waitcnt lgkmcnt(8)
    v_mfma_f32_16x16x32_bf16 v[44:47], v[112:115], v[80:83], v[44:47]
    v_mfma_f32_16x16x32_bf16 v[40:43], v[112:115], v[88:91], v[40:43]
    v_mfma_f32_16x16x32_bf16 v[36:39], v[112:115], v[96:99], v[36:39]
    v_mfma_f32_16x16x32_bf16 v[32:35], v[112:115], v[104:107], v[32:35]
    s_add_u32 m0, s43, 81920
    s_mov_b32 s67, 286720
    buffer_load_dwordx4 v250, s[52:55], s67 offen lds
    ds_read_b64 v[112:113], v244 offset:896
    ds_read_b64 v[114:115], v244 offset:904
    s_waitcnt lgkmcnt(6)
    v_mfma_f32_16x16x32_bf16 v[44:47], v[116:119], v[84:87], v[44:47]
    v_mfma_f32_16x16x32_bf16 v[40:43], v[116:119], v[92:95], v[40:43]
    v_mfma_f32_16x16x32_bf16 v[36:39], v[116:119], v[100:103], v[36:39]
    v_mfma_f32_16x16x32_bf16 v[32:35], v[116:119], v[108:111], v[32:35]
    s_add_u32 m0, s43, 90112
    s_mov_b32 s67, 344064
    buffer_load_dwordx4 v250, s[52:55], s67 offen lds
    ds_read_b64 v[116:117], v244 offset:640
    ds_read_b64 v[118:119], v244 offset:648
    s_waitcnt lgkmcnt(6)
    v_mfma_f32_16x16x32_bf16 v[44:47], v[120:123], v[88:91], v[44:47]
    v_mfma_f32_16x16x32_bf16 v[40:43], v[120:123], v[96:99], v[40:43]
    v_mfma_f32_16x16x32_bf16 v[36:39], v[120:123], v[104:107], v[36:39]
    s_add_u32 m0, s43, 98304
    s_mov_b32 s67, 401408
    buffer_load_dwordx4 v250, s[52:55], s67 offen lds
    ds_read_b64 v[120:121], v244 offset:384
    ds_read_b64 v[122:123], v244 offset:392
    s_waitcnt lgkmcnt(6)
    v_mfma_f32_16x16x32_bf16 v[44:47], v[124:127], v[92:95], v[44:47]
    v_mfma_f32_16x16x32_bf16 v[40:43], v[124:127], v[100:103], v[40:43]
    v_mfma_f32_16x16x32_bf16 v[36:39], v[124:127], v[108:111], v[36:39]
    s_add_u32 m0, s43, 106496
    s_mov_b32 s67, 458752
    buffer_load_dwordx4 v250, s[52:55], s67 offen lds
    ds_read_b64 v[124:125], v244 offset:128
    ds_read_b64 v[126:127], v244 offset:136
    s_waitcnt lgkmcnt(6)
    v_mfma_f32_16x16x32_bf16 v[44:47], v[112:115], v[96:99], v[44:47]
    v_mfma_f32_16x16x32_bf16 v[40:43], v[112:115], v[104:107], v[40:43]
    s_waitcnt lgkmcnt(4)
    v_mfma_f32_16x16x32_bf16 v[44:47], v[116:119], v[100:103], v[44:47]
    v_mfma_f32_16x16x32_bf16 v[40:43], v[116:119], v[108:111], v[40:43]
    ds_write_b128 v6, v[32:35]
    ds_write_b128 v6, v[36:39] offset:1024
    s_waitcnt lgkmcnt(4)
    v_mfma_f32_16x16x32_bf16 v[44:47], v[120:123], v[104:107], v[44:47]
    s_waitcnt lgkmcnt(2)
    v_mfma_f32_16x16x32_bf16 v[44:47], v[124:127], v[108:111], v[44:47]
    s_nop 1
    ds_write_b128 v7, v[40:43]
    s_nop 4
    ds_write_b128 v7, v[44:47] offset:1024
    s_mul_i32 s64, s32, 6144
    s_add_u32 s64, s64, 114688
    v_add_u32 v3, s64, v2
    s_waitcnt lgkmcnt(0)
    s_barrier
    ds_read_b128 v[48:51], v3 offset:0
    ds_read_b128 v[52:55], v3 offset:1024
    ds_read_b128 v[56:59], v3 offset:2048
    ds_read_b128 v[60:63], v3 offset:3072
    ds_read_b128 v[64:67], v3 offset:4096
    ds_read_b128 v[68:71], v3 offset:5120
    s_waitcnt lgkmcnt(0)
    v_add_f32 v24, v24, v48
    v_add_f32 v25, v25, v49
    v_add_f32 v26, v26, v50
    v_add_f32 v27, v27, v51
    v_add_f32 v28, v28, v52
    v_add_f32 v29, v29, v53
    v_add_f32 v30, v30, v54
    v_add_f32 v31, v31, v55
    v_add_f32 v24, v24, v56
    v_add_f32 v25, v25, v57
    v_add_f32 v26, v26, v58
    v_add_f32 v27, v27, v59
    v_add_f32 v28, v28, v60
    v_add_f32 v29, v29, v61
    v_add_f32 v30, v30, v62
    v_add_f32 v31, v31, v63
    v_add_f32 v24, v24, v64
    v_add_f32 v25, v25, v65
    v_add_f32 v26, v26, v66
    v_add_f32 v27, v27, v67
    v_add_f32 v28, v28, v68
    v_add_f32 v29, v29, v69
    v_add_f32 v30, v30, v70
    v_add_f32 v31, v31, v71
    v_cvt_pk_bf16_f32 v80, v24, v25
    v_cvt_pk_bf16_f32 v81, v26, v27
    buffer_store_dwordx2 v[80:81], v247, s[56:59], 0 offen offset:1024 sc1
    v_cvt_pk_bf16_f32 v82, v28, v29
    v_cvt_pk_bf16_f32 v83, v30, v31
    buffer_store_dwordx2 v[82:83], v247, s[56:59], 0 offen offset:1536 sc1
    s_branch L_conv_done
L_conv2:
    v_lshlrev_b32 v2, 4, v1
    s_lshl_b32 s64, s34, 2
    s_add_u32 s64, s64, 0
    s_mul_i32 s64, s64, 6144
    s_add_u32 s64, s64, 116736
    v_add_u32 v4, s64, v2
    s_lshl_b32 s64, s34, 2
    s_add_u32 s64, s64, 1
    s_mul_i32 s64, s64, 6144
    s_add_u32 s64, s64, 116736
    v_add_u32 v5, s64, v2
    s_lshl_b32 s64, s34, 2
    s_add_u32 s64, s64, 3
    s_mul_i32 s64, s64, 6144
    s_add_u32 s64, s64, 118784
    v_add_u32 v7, s64, v2
    ds_read_b64 v[112:113], v244 offset:3904
    ds_read_b64 v[114:115], v244 offset:3912
    ds_read_b128 v[48:51], v245 offset:3904
    ds_read_b128 v[56:59], v245 offset:3392
    ds_read_b128 v[64:67], v245 offset:2880
    ds_read_b128 v[72:75], v245 offset:2368
    ds_read_b128 v[80:83], v245 offset:1856
    ds_read_b128 v[88:91], v245 offset:1344
    ds_read_b128 v[96:99], v245 offset:832
    ds_read_b128 v[104:107], v245 offset:320
    ds_read_b64 v[116:117], v244 offset:3648
    ds_read_b64 v[118:119], v244 offset:3656
    v_mov_b32 v16, 0
    v_mov_b32 v17, 0
    v_mov_b32 v18, 0
    v_mov_b32 v19, 0
    v_mov_b32 v20, 0
    v_mov_b32 v21, 0
    v_mov_b32 v22, 0
    v_mov_b32 v23, 0
    v_mov_b32 v24, 0
    v_mov_b32 v25, 0
    v_mov_b32 v26, 0
    v_mov_b32 v27, 0
    v_mov_b32 v28, 0
    v_mov_b32 v29, 0
    v_mov_b32 v30, 0
    v_mov_b32 v31, 0
    v_mov_b32 v32, 0
    v_mov_b32 v33, 0
    v_mov_b32 v34, 0
    v_mov_b32 v35, 0
    v_mov_b32 v36, 0
    v_mov_b32 v37, 0
    v_mov_b32 v38, 0
    v_mov_b32 v39, 0
    v_mov_b32 v40, 0
    v_mov_b32 v41, 0
    v_mov_b32 v42, 0
    v_mov_b32 v43, 0
    v_mov_b32 v44, 0
    v_mov_b32 v45, 0
    v_mov_b32 v46, 0
    v_mov_b32 v47, 0
    ds_read_b128 v[52:55], v245 offset:3648
    ds_read_b128 v[60:63], v245 offset:3136
    ds_read_b128 v[68:71], v245 offset:2624
    ds_read_b128 v[76:79], v245 offset:2112
    ds_read_b128 v[84:87], v245 offset:1600
    ds_read_b128 v[92:95], v245 offset:1088
    ds_read_b128 v[100:103], v245 offset:576
    ds_read_b128 v[108:111], v245 offset:64
    ds_read_b64 v[120:121], v244 offset:3392
    ds_read_b64 v[122:123], v244 offset:3400
    ds_read_b64 v[124:125], v244 offset:3136
    ds_read_b64 v[126:127], v244 offset:3144
    s_waitcnt lgkmcnt(14)
    v_mfma_f32_16x16x32_bf16 v[44:47], v[112:115], v[48:51], v[44:47]
    v_mfma_f32_16x16x32_bf16 v[40:43], v[112:115], v[56:59], v[40:43]
    v_mfma_f32_16x16x32_bf16 v[36:39], v[112:115], v[64:67], v[36:39]
    v_mfma_f32_16x16x32_bf16 v[32:35], v[112:115], v[72:75], v[32:35]
    v_mfma_f32_16x16x32_bf16 v[28:31], v[112:115], v[80:83], v[28:31]
    v_mfma_f32_16x16x32_bf16 v[24:27], v[112:115], v[88:91], v[24:27]
    v_mfma_f32_16x16x32_bf16 v[20:23], v[112:115], v[96:99], v[20:23]
    v_mfma_f32_16x16x32_bf16 v[16:19], v[112:115], v[104:107], v[16:19]
    ds_read_b64 v[112:113], v244 offset:2880
    ds_read_b64 v[114:115], v244 offset:2888
    s_waitcnt lgkmcnt(6)
    s_barrier
    v_mfma_f32_16x16x32_bf16 v[44:47], v[116:119], v[52:55], v[44:47]
    v_mfma_f32_16x16x32_bf16 v[40:43], v[116:119], v[60:63], v[40:43]
    v_mfma_f32_16x16x32_bf16 v[36:39], v[116:119], v[68:71], v[36:39]
    v_mfma_f32_16x16x32_bf16 v[32:35], v[116:119], v[76:79], v[32:35]
    v_mfma_f32_16x16x32_bf16 v[28:31], v[116:119], v[84:87], v[28:31]
    v_mfma_f32_16x16x32_bf16 v[24:27], v[116:119], v[92:95], v[24:27]
    v_mfma_f32_16x16x32_bf16 v[20:23], v[116:119], v[100:103], v[20:23]
    v_mfma_f32_16x16x32_bf16 v[16:19], v[116:119], v[108:111], v[16:19]
    ds_read_b64 v[116:117], v244 offset:2624
    ds_read_b64 v[118:119], v244 offset:2632
    s_waitcnt lgkmcnt(6)
    v_mfma_f32_16x16x32_bf16 v[44:47], v[120:123], v[56:59], v[44:47]
    v_mfma_f32_16x16x32_bf16 v[40:43], v[120:123], v[64:67], v[40:43]
    v_mfma_f32_16x16x32_bf16 v[36:39], v[120:123], v[72:75], v[36:39]
    v_mfma_f32_16x16x32_bf16 v[32:35], v[120:123], v[80:83], v[32:35]
    v_mfma_f32_16x16x32_bf16 v[28:31], v[120:123], v[88:91], v[28:31]
    v_mfma_f32_16x16x32_bf16 v[24:27], v[120:123], v[96:99], v[24:27]
    v_mfma_f32_16x16x32_bf16 v[20:23], v[120:123], v[104:107], v[20:23]
    ds_read_b64 v[120:121], v244 offset:2368
    ds_read_b64 v[122:123], v244 offset:2376
    s_waitcnt lgkmcnt(6)
    v_mfma_f32_16x16x32_bf16 v[44:47], v[124:127], v[60:63], v[44:47]
    v_mfma_f32_16x16x32_bf16 v[40:43], v[124:127], v[68:71], v[40:43]
    v_mfma_f32_16x16x32_bf16 v[36:39], v[124:127], v[76:79], v[36:39]
    v_mfma_f32_16x16x32_bf16 v[32:35], v[124:127], v[84:87], v[32:35]
    v_mfma_f32_16x16x32_bf16 v[28:31], v[124:127], v[92:95], v[28:31]
    v_mfma_f32_16x16x32_bf16 v[24:27], v[124:127], v[100:103], v[24:27]
    v_mfma_f32_16x16x32_bf16 v[20:23], v[124:127], v[108:111], v[20:23]
    ds_read_b64 v[124:125], v244 offset:2112
    ds_read_b64 v[126:127], v244 offset:2120
    s_waitcnt lgkmcnt(6)
    v_mfma_f32_16x16x32_bf16 v[44:47], v[112:115], v[64:67], v[44:47]
    v_mfma_f32_16x16x32_bf16 v[40:43], v[112:115], v[72:75], v[40:43]
    v_mfma_f32_16x16x32_bf16 v[36:39], v[112:115], v[80:83], v[36:39]
    v_mfma_f32_16x16x32_bf16 v[32:35], v[112:115], v[88:91], v[32:35]
    v_mfma_f32_16x16x32_bf16 v[28:31], v[112:115], v[96:99], v[28:31]
    v_mfma_f32_16x16x32_bf16 v[24:27], v[112:115], v[104:107], v[24:27]
    ds_read_b64 v[112:113], v244 offset:1856
    ds_read_b64 v[114:115], v244 offset:1864
    s_waitcnt lgkmcnt(6)
    v_mfma_f32_16x16x32_bf16 v[44:47], v[116:119], v[68:71], v[44:47]
    v_mfma_f32_16x16x32_bf16 v[40:43], v[116:119], v[76:79], v[40:43]
    v_mfma_f32_16x16x32_bf16 v[36:39], v[116:119], v[84:87], v[36:39]
    v_mfma_f32_16x16x32_bf16 v[32:35], v[116:119], v[92:95], v[32:35]
    v_mfma_f32_16x16x32_bf16 v[28:31], v[116:119], v[100:103], v[28:31]
    v_mfma_f32_16x16x32_bf16 v[24:27], v[116:119], v[108:111], v[24:27]
    ds_write_b128 v4, v[16:19]
    ds_write_b128 v4, v[20:23] offset:1024
    s_add_u32 m0, s43, 40960
    s_mov_b32 s67, 0
    buffer_load_dwordx4 v250, s[52:55], s67 offen lds
    ds_read_b64 v[116:117], v244 offset:1600
    ds_read_b64 v[118:119], v244 offset:1608
    s_waitcnt lgkmcnt(8)
    v_mfma_f32_16x16x32_bf16 v[44:47], v[120:123], v[72:75], v[44:47]
    v_mfma_f32_16x16x32_bf16 v[40:43], v[120:123], v[80:83], v[40:43]
    v_mfma_f32_16x16x32_bf16 v[36:39], v[120:123], v[88:91], v[36:39]
    v_mfma_f32_16x16x32_bf16 v[32:35], v[120:123], v[96:99], v[32:35]
    v_mfma_f32_16x16x32_bf16 v[28:31], v[120:123], v[104:107], v[28:31]
    s_add_u32 m0, s43, 49152
    s_mov_b32 s67, 57344
    buffer_load_dwordx4 v250, s[52:55], s67 offen lds
    ds_read_b64 v[120:121], v244 offset:1344
    ds_read_b64 v[122:123], v244 offset:1352
    s_waitcnt lgkmcnt(8)
    v_mfma_f32_16x16x32_bf16 v[44:47], v[124:127], v[76:79], v[44:47]
    v_mfma_f32_16x16x32_bf16 v[40:43], v[124:127], v[84:87], v[40:43]
    v_mfma_f32_16x16x32_bf16 v[36:39], v[124:127], v[92:95], v[36:39]
    v_mfma_f32_16x16x32_bf16 v[32:35], v[124:127], v[100:103], v[32:35]
    v_mfma_f32_16x16x32_bf16 v[28:31], v[124:127], v[108:111], v[28:31]
    s_add_u32 m0, s43, 57344
    s_mov_b32 s67, 114688
    buffer_load_dwordx4 v250, s[52:55], s67 offen lds
    ds_read_b64 v[124:125], v244 offset:1088
    ds_read_b64 v[126:127], v244 offset:1096
    s_waitcnt lgkmcnt(8)
    v_mfma_f32_16x16x32_bf16 v[44:47], v[112:115], v[80:83], v[44:47]
    v_mfma_f32_16x16x32_bf16 v[40:43], v[112:115], v[88:91], v[40:43]
    v_mfma_f32_16x16x32_bf16 v[36:39], v[112:115], v[96:99], v[36:39]
    v_mfma_f32_16x16x32_bf16 v[32:35], v[112:115], v[104:107], v[32:35]
    s_add_u32 m0, s43, 65536
    s_mov_b32 s67, 172032
    buffer_load_dwordx4 v250, s[52:55], s67 offen lds
    ds_read_b64 v[112:113], v244 offset:832
    ds_read_b64 v[114:115], v244 offset:840
    s_waitcnt lgkmcnt(6)
    v_mfma_f32_16x16x32_bf16 v[44:47], v[116:119], v[84:87], v[44:47]
    v_mfma_f32_16x16x32_bf16 v[40:43], v[116:119], v[92:95], v[40:43]
    v_mfma_f32_16x16x32_bf16 v[36:39], v[116:119], v[100:103], v[36:39]
    v_mfma_f32_16x16x32_bf16 v[32:35], v[116:119], v[108:111], v[32:35]
    ds_write_b128 v5, v[24:27]
    ds_write_b128 v5, v[28:31] offset:1024
    s_add_u32 m0, s43, 73728
    s_mov_b32 s67, 229376
    buffer_load_dwordx4 v250, s[52:55], s67 offen lds
    ds_read_b64 v[116:117], v244 offset:576
    ds_read_b64 v[118:119], v244 offset:584
    s_waitcnt lgkmcnt(8)
    v_mfma_f32_16x16x32_bf16 v[44:47], v[120:123], v[88:91], v[44:47]
    v_mfma_f32_16x16x32_bf16 v[40:43], v[120:123], v[96:99], v[40:43]
    v_mfma_f32_16x16x32_bf16 v[36:39], v[120:123], v[104:107], v[36:39]
    s_add_u32 m0, s43, 81920
    s_mov_b32 s67, 286720
    buffer_load_dwordx4 v250, s[52:55], s67 offen lds
    ds_read_b64 v[120:121], v244 offset:320
    ds_read_b64 v[122:123], v244 offset:328
    s_waitcnt lgkmcnt(8)
    v_mfma_f32_16x16x32_bf16 v[44:47], v[124:127], v[92:95], v[44:47]
    v_mfma_f32_16x16x32_bf16 v[40:43], v[124:127], v[100:103], v[40:43]
    v_mfma_f32_16x16x32_bf16 v[36:39], v[124:127], v[108:111], v[36:39]
    s_add_u32 m0, s43, 90112
    s_mov_b32 s67, 344064
    buffer_load_dwordx4 v250, s[52:55], s67 offen lds
    ds_read_b64 v[124:125], v244 offset:64
    ds_read_b64 v[126:127], v244 offset:72
    s_waitcnt lgkmcnt(8)
    v_mfma_f32_16x16x32_bf16 v[44:47], v[112:115], v[96:99], v[44:47]
    v_mfma_f32_16x16x32_bf16 v[40:43], v[112:115], v[104:107], v[40:43]
    s_add_u32 m0, s43, 98304
    s_mov_b32 s67, 401408
    buffer_load_dwordx4 v250, s[52:55], s67 offen lds
    s_waitcnt lgkmcnt(4)
    v_mfma_f32_16x16x32_bf16 v[44:47], v[116:119], v[100:103], v[44:47]
    v_mfma_f32_16x16x32_bf16 v[40:43], v[116:119], v[108:111], v[40:43]
    s_add_u32 m0, s43, 106496
    s_mov_b32 s67, 458752
    buffer_load_dwordx4 v250, s[52:55], s67 offen lds
    s_waitcnt lgkmcnt(2)
    v_mfma_f32_16x16x32_bf16 v[44:47], v[120:123], v[104:107], v[44:47]
    s_waitcnt lgkmcnt(0)
    v_mfma_f32_16x16x32_bf16 v[44:47], v[124:127], v[108:111], v[44:47]
    s_nop 0
    ds_write_b128 v7, v[40:43]
    s_nop 5
    ds_write_b128 v7, v[44:47] offset:1024
    s_mul_i32 s64, s32, 6144
    s_add_u32 s64, s64, 114688
    v_add_u32 v3, s64, v2
    s_waitcnt lgkmcnt(0)
    s_barrier
    ds_read_b128 v[48:51], v3 offset:0
    ds_read_b128 v[52:55], v3 offset:1024
    ds_read_b128 v[56:59], v3 offset:2048
    ds_read_b128 v[60:63], v3 offset:3072
    ds_read_b128 v[64:67], v3 offset:4096
    ds_read_b128 v[68:71], v3 offset:5120
    s_waitcnt lgkmcnt(0)
    v_add_f32 v32, v32, v48
    v_add_f32 v33, v33, v49
    v_add_f32 v34, v34, v50
    v_add_f32 v35, v35, v51
    v_add_f32 v36, v36, v52
    v_add_f32 v37, v37, v53
    v_add_f32 v38, v38, v54
    v_add_f32 v39, v39, v55
    v_add_f32 v32, v32, v56
    v_add_f32 v33, v33, v57
    v_add_f32 v34, v34, v58
    v_add_f32 v35, v35, v59
    v_add_f32 v36, v36, v60
    v_add_f32 v37, v37, v61
    v_add_f32 v38, v38, v62
    v_add_f32 v39, v39, v63
    v_add_f32 v32, v32, v64
    v_add_f32 v33, v33, v65
    v_add_f32 v34, v34, v66
    v_add_f32 v35, v35, v67
    v_add_f32 v36, v36, v68
    v_add_f32 v37, v37, v69
    v_add_f32 v38, v38, v70
    v_add_f32 v39, v39, v71
    v_cvt_pk_bf16_f32 v80, v32, v33
    v_cvt_pk_bf16_f32 v81, v34, v35
    buffer_store_dwordx2 v[80:81], v247, s[56:59], 0 offen offset:2048 sc1
    v_cvt_pk_bf16_f32 v82, v36, v37
    v_cvt_pk_bf16_f32 v83, v38, v39
    buffer_store_dwordx2 v[82:83], v247, s[56:59], 0 offen offset:2560 sc1
    s_branch L_conv_done
L_conv3:
    v_lshlrev_b32 v2, 4, v1
    s_lshl_b32 s64, s34, 2
    s_add_u32 s64, s64, 0
    s_mul_i32 s64, s64, 6144
    s_add_u32 s64, s64, 118784
    v_add_u32 v4, s64, v2
    s_lshl_b32 s64, s34, 2
    s_add_u32 s64, s64, 1
    s_mul_i32 s64, s64, 6144
    s_add_u32 s64, s64, 118784
    v_add_u32 v5, s64, v2
    s_lshl_b32 s64, s34, 2
    s_add_u32 s64, s64, 2
    s_mul_i32 s64, s64, 6144
    s_add_u32 s64, s64, 118784
    v_add_u32 v6, s64, v2
    ds_read_b64 v[112:113], v244 offset:3840
    ds_read_b64 v[114:115], v244 offset:3848
    ds_read_b128 v[48:51], v245 offset:3840
    ds_read_b128 v[56:59], v245 offset:3328
    ds_read_b128 v[64:67], v245 offset:2816
    ds_read_b128 v[72:75], v245 offset:2304
    ds_read_b128 v[80:83], v245 offset:1792
    ds_read_b128 v[88:91], v245 offset:1280
    ds_read_b128 v[96:99], v245 offset:768
    ds_read_b128 v[104:107], v245 offset:256
    ds_read_b64 v[116:117], v244 offset:3584
    ds_read_b64 v[118:119], v244 offset:3592
    v_mov_b32 v16, 0
    v_mov_b32 v17, 0
    v_mov_b32 v18, 0
    v_mov_b32 v19, 0
    v_mov_b32 v20, 0
    v_mov_b32 v21, 0
    v_mov_b32 v22, 0
    v_mov_b32 v23, 0
    v_mov_b32 v24, 0
    v_mov_b32 v25, 0
    v_mov_b32 v26, 0
    v_mov_b32 v27, 0
    v_mov_b32 v28, 0
    v_mov_b32 v29, 0
    v_mov_b32 v30, 0
    v_mov_b32 v31, 0
    v_mov_b32 v32, 0
    v_mov_b32 v33, 0
    v_mov_b32 v34, 0
    v_mov_b32 v35, 0
    v_mov_b32 v36, 0
    v_mov_b32 v37, 0
    v_mov_b32 v38, 0
    v_mov_b32 v39, 0
    v_mov_b32 v40, 0
    v_mov_b32 v41, 0
    v_mov_b32 v42, 0
    v_mov_b32 v43, 0
    v_mov_b32 v44, 0
    v_mov_b32 v45, 0
    v_mov_b32 v46, 0
    v_mov_b32 v47, 0
    ds_read_b128 v[52:55], v245 offset:3584
    ds_read_b128 v[60:63], v245 offset:3072
    ds_read_b128 v[68:71], v245 offset:2560
    ds_read_b128 v[76:79], v245 offset:2048
    ds_read_b128 v[84:87], v245 offset:1536
    ds_read_b128 v[92:95], v245 offset:1024
    ds_read_b128 v[100:103], v245 offset:512
    ds_read_b128 v[108:111], v245 offset:0
    ds_read_b64 v[120:121], v244 offset:3328
    ds_read_b64 v[122:123], v244 offset:3336
    ds_read_b64 v[124:125], v244 offset:3072
    ds_read_b64 v[126:127], v244 offset:3080
    s_waitcnt lgkmcnt(14)
    v_mfma_f32_16x16x32_bf16 v[44:47], v[112:115], v[48:51], v[44:47]
    v_mfma_f32_16x16x32_bf16 v[40:43], v[112:115], v[56:59], v[40:43]
    v_mfma_f32_16x16x32_bf16 v[36:39], v[112:115], v[64:67], v[36:39]
    v_mfma_f32_16x16x32_bf16 v[32:35], v[112:115], v[72:75], v[32:35]
    v_mfma_f32_16x16x32_bf16 v[28:31], v[112:115], v[80:83], v[28:31]
    v_mfma_f32_16x16x32_bf16 v[24:27], v[112:115], v[88:91], v[24:27]
    v_mfma_f32_16x16x32_bf16 v[20:23], v[112:115], v[96:99], v[20:23]
    v_mfma_f32_16x16x32_bf16 v[16:19], v[112:115], v[104:107], v[16:19]
    ds_read_b64 v[112:113], v244 offset:2816
    ds_read_b64 v[114:115], v244 offset:2824
    s_waitcnt lgkmcnt(6)
    s_barrier
    v_mfma_f32_16x16x32_bf16 v[44:47], v[116:119], v[52:55], v[44:47]
    v_mfma_f32_16x16x32_bf16 v[40:43], v[116:119], v[60:63], v[40:43]
    v_mfma_f32_16x16x32_bf16 v[36:39], v[116:119], v[68:71], v[36:39]
    v_mfma_f32_16x16x32_bf16 v[32:35], v[116:119], v[76:79], v[32:35]
    v_mfma_f32_16x16x32_bf16 v[28:31], v[116:119], v[84:87], v[28:31]
    v_mfma_f32_16x16x32_bf16 v[24:27], v[116:119], v[92:95], v[24:27]
    v_mfma_f32_16x16x32_bf16 v[20:23], v[116:119], v[100:103], v[20:23]
    v_mfma_f32_16x16x32_bf16 v[16:19], v[116:119], v[108:111], v[16:19]
    ds_read_b64 v[116:117], v244 offset:2560
    ds_read_b64 v[118:119], v244 offset:2568
    s_waitcnt lgkmcnt(6)
    v_mfma_f32_16x16x32_bf16 v[44:47], v[120:123], v[56:59], v[44:47]
    v_mfma_f32_16x16x32_bf16 v[40:43], v[120:123], v[64:67], v[40:43]
    v_mfma_f32_16x16x32_bf16 v[36:39], v[120:123], v[72:75], v[36:39]
    v_mfma_f32_16x16x32_bf16 v[32:35], v[120:123], v[80:83], v[32:35]
    v_mfma_f32_16x16x32_bf16 v[28:31], v[120:123], v[88:91], v[28:31]
    v_mfma_f32_16x16x32_bf16 v[24:27], v[120:123], v[96:99], v[24:27]
    v_mfma_f32_16x16x32_bf16 v[20:23], v[120:123], v[104:107], v[20:23]
    ds_read_b64 v[120:121], v244 offset:2304
    ds_read_b64 v[122:123], v244 offset:2312
    s_waitcnt lgkmcnt(6)
    v_mfma_f32_16x16x32_bf16 v[44:47], v[124:127], v[60:63], v[44:47]
    v_mfma_f32_16x16x32_bf16 v[40:43], v[124:127], v[68:71], v[40:43]
    v_mfma_f32_16x16x32_bf16 v[36:39], v[124:127], v[76:79], v[36:39]
    v_mfma_f32_16x16x32_bf16 v[32:35], v[124:127], v[84:87], v[32:35]
    v_mfma_f32_16x16x32_bf16 v[28:31], v[124:127], v[92:95], v[28:31]
    v_mfma_f32_16x16x32_bf16 v[24:27], v[124:127], v[100:103], v[24:27]
    v_mfma_f32_16x16x32_bf16 v[20:23], v[124:127], v[108:111], v[20:23]
    ds_read_b64 v[124:125], v244 offset:2048
    ds_read_b64 v[126:127], v244 offset:2056
    s_waitcnt lgkmcnt(6)
    v_mfma_f32_16x16x32_bf16 v[44:47], v[112:115], v[64:67], v[44:47]
    v_mfma_f32_16x16x32_bf16 v[40:43], v[112:115], v[72:75], v[40:43]
    v_mfma_f32_16x16x32_bf16 v[36:39], v[112:115], v[80:83], v[36:39]
    v_mfma_f32_16x16x32_bf16 v[32:35], v[112:115], v[88:91], v[32:35]
    v_mfma_f32_16x16x32_bf16 v[28:31], v[112:115], v[96:99], v[28:31]
    v_mfma_f32_16x16x32_bf16 v[24:27], v[112:115], v[104:107], v[24:27]
    ds_read_b64 v[112:113], v244 offset:1792
    ds_read_b64 v[114:115], v244 offset:1800
    s_waitcnt lgkmcnt(6)
    v_mfma_f32_16x16x32_bf16 v[44:47], v[116:119], v[68:71], v[44:47]
    v_mfma_f32_16x16x32_bf16 v[40:43], v[116:119], v[76:79], v[40:43]
    v_mfma_f32_16x16x32_bf16 v[36:39], v[116:119], v[84:87], v[36:39]
    v_mfma_f32_16x16x32_bf16 v[32:35], v[116:119], v[92:95], v[32:35]
    v_mfma_f32_16x16x32_bf16 v[28:31], v[116:119], v[100:103], v[28:31]
    v_mfma_f32_16x16x32_bf16 v[24:27], v[116:119], v[108:111], v[24:27]
    ds_write_b128 v4, v[16:19]
    ds_write_b128 v4, v[20:23] offset:1024
    ds_read_b64 v[116:117], v244 offset:1536
    ds_read_b64 v[118:119], v244 offset:1544
    s_waitcnt lgkmcnt(8)
    v_mfma_f32_16x16x32_bf16 v[44:47], v[120:123], v[72:75], v[44:47]
    v_mfma_f32_16x16x32_bf16 v[40:43], v[120:123], v[80:83], v[40:43]
    v_mfma_f32_16x16x32_bf16 v[36:39], v[120:123], v[88:91], v[36:39]
    v_mfma_f32_16x16x32_bf16 v[32:35], v[120:123], v[96:99], v[32:35]
    v_mfma_f32_16x16x32_bf16 v[28:31], v[120:123], v[104:107], v[28:31]
    ds_read_b64 v[120:121], v244 offset:1280
    ds_read_b64 v[122:123], v244 offset:1288
    s_waitcnt lgkmcnt(8)
    v_mfma_f32_16x16x32_bf16 v[44:47], v[124:127], v[76:79], v[44:47]
    v_mfma_f32_16x16x32_bf16 v[40:43], v[124:127], v[84:87], v[40:43]
    v_mfma_f32_16x16x32_bf16 v[36:39], v[124:127], v[92:95], v[36:39]
    v_mfma_f32_16x16x32_bf16 v[32:35], v[124:127], v[100:103], v[32:35]
    v_mfma_f32_16x16x32_bf16 v[28:31], v[124:127], v[108:111], v[28:31]
    s_add_u32 m0, s43, 40960
    s_mov_b32 s67, 0
    buffer_load_dwordx4 v250, s[52:55], s67 offen lds
    ds_read_b64 v[124:125], v244 offset:1024
    ds_read_b64 v[126:127], v244 offset:1032
    s_waitcnt lgkmcnt(8)
    v_mfma_f32_16x16x32_bf16 v[44:47], v[112:115], v[80:83], v[44:47]
    v_mfma_f32_16x16x32_bf16 v[40:43], v[112:115], v[88:91], v[40:43]
    v_mfma_f32_16x16x32_bf16 v[36:39], v[112:115], v[96:99], v[36:39]
    v_mfma_f32_16x16x32_bf16 v[32:35], v[112:115], v[104:107], v[32:35]
    s_add_u32 m0, s43, 49152
    s_mov_b32 s67, 57344
    buffer_load_dwordx4 v250, s[52:55], s67 offen lds
    ds_read_b64 v[112:113], v244 offset:768
    ds_read_b64 v[114:115], v244 offset:776
    s_waitcnt lgkmcnt(6)
    v_mfma_f32_16x16x32_bf16 v[44:47], v[116:119], v[84:87], v[44:47]
    v_mfma_f32_16x16x32_bf16 v[40:43], v[116:119], v[92:95], v[40:43]
    v_mfma_f32_16x16x32_bf16 v[36:39], v[116:119], v[100:103], v[36:39]
    v_mfma_f32_16x16x32_bf16 v[32:35], v[116:119], v[108:111], v[32:35]
    ds_write_b128 v5, v[24:27]
    ds_write_b128 v5, v[28:31] offset:1024
    s_add_u32 m0, s43, 57344
    s_mov_b32 s67, 114688
    buffer_load_dwordx4 v250, s[52:55], s67 offen lds
    ds_read_b64 v[116:117], v244 offset:512
    ds_read_b64 v[118:119], v244 offset:520
    s_waitcnt lgkmcnt(8)
    v_mfma_f32_16x16x32_bf16 v[44:47], v[120:123], v[88:91], v[44:47]
    v_mfma_f32_16x16x32_bf16 v[40:43], v[120:123], v[96:99], v[40:43]
    v_mfma_f32_16x16x32_bf16 v[36:39], v[120:123], v[104:107], v[36:39]
    s_add_u32 m0, s43, 65536
    s_mov_b32 s67, 172032
    buffer_load_dwordx4 v250, s[52:55], s67 offen lds
    ds_read_b64 v[120:121], v244 offset:256
    ds_read_b64 v[122:123], v244 offset:264
    s_waitcnt lgkmcnt(8)
    v_mfma_f32_16x16x32_bf16 v[44:47], v[124:127], v[92:95], v[44:47]
    v_mfma_f32_16x16x32_bf16 v[40:43], v[124:127], v[100:103], v[40:43]
    v_mfma_f32_16x16x32_bf16 v[36:39], v[124:127], v[108:111], v[36:39]
    s_add_u32 m0, s43, 73728
    s_mov_b32 s67, 229376
    buffer_load_dwordx4 v250, s[52:55], s67 offen lds
    ds_read_b64 v[124:125], v244 offset:0
    ds_read_b64 v[126:127], v244 offset:8
    s_waitcnt lgkmcnt(8)
    v_mfma_f32_16x16x32_bf16 v[44:47], v[112:115], v[96:99], v[44:47]
    v_mfma_f32_16x16x32_bf16 v[40:43], v[112:115], v[104:107], v[40:43]
    s_add_u32 m0, s43, 81920
    s_mov_b32 s67, 286720
    buffer_load_dwordx4 v250, s[52:55], s67 offen lds
    s_waitcnt lgkmcnt(4)
    v_mfma_f32_16x16x32_bf16 v[44:47], v[116:119], v[100:103], v[44:47]
    v_mfma_f32_16x16x32_bf16 v[40:43], v[116:119], v[108:111], v[40:43]
    ds_write_b128 v6, v[32:35]
    ds_write_b128 v6, v[36:39] offset:1024
    s_add_u32 m0, s43, 90112
    s_mov_b32 s67, 344064
    buffer_load_dwordx4 v250, s[52:55], s67 offen lds
    s_waitcnt lgkmcnt(4)
    v_mfma_f32_16x16x32_bf16 v[44:47], v[120:123], v[104:107], v[44:47]
    s_add_u32 m0, s43, 98304
    s_mov_b32 s67, 401408
    buffer_load_dwordx4 v250, s[52:55], s67 offen lds
    s_waitcnt lgkmcnt(2)
    v_mfma_f32_16x16x32_bf16 v[44:47], v[124:127], v[108:111], v[44:47]
    s_add_u32 m0, s43, 106496
    s_mov_b32 s67, 458752
    buffer_load_dwordx4 v250, s[52:55], s67 offen lds
    s_mul_i32 s64, s32, 6144
    s_add_u32 s64, s64, 114688
    v_add_u32 v3, s64, v2
    s_waitcnt lgkmcnt(0)
    s_barrier
    ds_read_b128 v[48:51], v3 offset:0
    ds_read_b128 v[52:55], v3 offset:1024
    ds_read_b128 v[56:59], v3 offset:2048
    ds_read_b128 v[60:63], v3 offset:3072
    ds_read_b128 v[64:67], v3 offset:4096
    ds_read_b128 v[68:71], v3 offset:5120
    s_waitcnt lgkmcnt(0)
    v_add_f32 v40, v40, v48
    v_add_f32 v41, v41, v49
    v_add_f32 v42, v42, v50
    v_add_f32 v43, v43, v51
    v_add_f32 v44, v44, v52
    v_add_f32 v45, v45, v53
    v_add_f32 v46, v46, v54
    v_add_f32 v47, v47, v55
    v_add_f32 v40, v40, v56
    v_add_f32 v41, v41, v57
    v_add_f32 v42, v42, v58
    v_add_f32 v43, v43, v59
    v_add_f32 v44, v44, v60
    v_add_f32 v45, v45, v61
    v_add_f32 v46, v46, v62
    v_add_f32 v47, v47, v63
    v_add_f32 v40, v40, v64
    v_add_f32 v41, v41, v65
    v_add_f32 v42, v42, v66
    v_add_f32 v43, v43, v67
    v_add_f32 v44, v44, v68
    v_add_f32 v45, v45, v69
    v_add_f32 v46, v46, v70
    v_add_f32 v47, v47, v71
    v_cvt_pk_bf16_f32 v80, v40, v41
    v_cvt_pk_bf16_f32 v81, v42, v43
    buffer_store_dwordx2 v[80:81], v247, s[56:59], 0 offen offset:3072 sc1
    v_cvt_pk_bf16_f32 v82, v44, v45
    v_cvt_pk_bf16_f32 v83, v46, v47
    buffer_store_dwordx2 v[82:83], v247, s[56:59], 0 offen offset:3584 sc1
L_conv_done:
    s_waitcnt vmcnt(0)
    s_barrier
    s_lshl_b32 s64, s2, 6
    s_add_u32 s64, s64, 65536
    s_cmp_eq_u32 s32, 0
    s_cbranch_scc0 L_pub_1963
    v_mov_b32 v2, s33
    v_mov_b32 v3, s64
    s_mov_b64 exec, 1
    buffer_store_dword v2, v3, s[56:59], 0 offen sc1
    s_mov_b64 exec, -1
L_pub_1963:
    v_lshrrev_b32 v8, 4, v1
    v_and_b32 v9, 1, v8
    v_lshrrev_b32 v10, 1, v8
    v_bfe_u32 v11, v1, 2, 2
    v_and_b32 v12, 3, v1
    v_lshl_add_u32 v13, v10, 3, v11
    v_and_b32 v14, 1, v12
    s_lshl_b32 s64, s32, 1
    v_add_u32 v14, s64, v14
    v_lshlrev_b32 v15, 1, v11
    v_add_u32 v15, v15, v9
    v_lshlrev_b32 v15, 1, v15
    v_xor_b32 v14, v14, v15
    v_lshlrev_b32 v14, 4, v14
    v_lshrrev_b32 v15, 1, v12
    v_lshl_add_u32 v14, v15, 3, v14
    v_lshl_add_u32 v14, v13, 8, v14
    v_lshl_add_u32 v14, v9, 12, v14
    s_lshl_b32 s64, s42, 10
    v_add_u32 v16, s64, v14
    s_xor_b32 s64, s64, 1024
    v_add_u32 v17, s64, v14
    v_add_u32 v18, 0x10000, v16
    v_add_u32 v19, 0x10000, v17
    ds_read_b64_tr_b16 v[128:129], v16 offset:40960
    ds_read_b64_tr_b16 v[130:131], v17 offset:40960
    ds_read_b64_tr_b16 v[132:133], v16 offset:49152
    ds_read_b64_tr_b16 v[134:135], v17 offset:49152
    ds_read_b64_tr_b16 v[136:137], v16 offset:57344
    ds_read_b64_tr_b16 v[138:139], v17 offset:57344
    ds_read_b64_tr_b16 v[140:141], v18 offset:0
    ds_read_b64_tr_b16 v[142:143], v19 offset:0
    ds_read_b64_tr_b16 v[144:145], v18 offset:8192
    ds_read_b64_tr_b16 v[146:147], v19 offset:8192
    ds_read_b64_tr_b16 v[148:149], v18 offset:16384
    ds_read_b64_tr_b16 v[150:151], v19 offset:16384
    ds_read_b64_tr_b16 v[152:153], v18 offset:24576
    ds_read_b64_tr_b16 v[154:155], v19 offset:24576
    ds_read_b64_tr_b16 v[156:157], v18 offset:32768
    ds_read_b64_tr_b16 v[158:159], v19 offset:32768
    ds_read_b64_tr_b16 v[160:161], v18 offset:40960
    ds_read_b64_tr_b16 v[162:163], v19 offset:40960
    s_waitcnt lgkmcnt(0)
    s_barrier
    s_add_u32 m0, s43, 0
    s_mov_b32 s67, 516096
    buffer_load_dwordx4 v250, s[52:55], s67 offen lds
    s_add_u32 m0, s43, 8192
    s_mov_b32 s67, 573440
    buffer_load_dwordx4 v250, s[52:55], s67 offen lds
    s_add_u32 m0, s43, 16384
    s_mov_b32 s67, 630784
    buffer_load_dwordx4 v250, s[52:55], s67 offen lds
    s_add_u32 m0, s43, 24576
    s_mov_b32 s67, 688128
    buffer_load_dwordx4 v250, s[52:55], s67 offen lds
    s_add_u32 m0, s43, 32768
    s_mov_b32 s67, 745472
    buffer_load_dwordx4 v250, s[52:55], s67 offen lds
    s_add_u32 m0, s43, 40960
    s_mov_b32 s67, 802816
    buffer_load_dwordx4 v250, s[52:55], s67 offen lds
    s_add_u32 m0, s43, 49152
    s_mov_b32 s67, 860160
    buffer_load_dwordx4 v250, s[52:55], s67 offen lds
    s_add_u32 m0, s43, 57344
    s_mov_b32 s67, 917504
    buffer_load_dwordx4 v250, s[52:55], s67 offen lds
    s_add_u32 m0, s43, 65536
    s_mov_b32 s67, 974848
    buffer_load_dwordx4 v250, s[52:55], s67 offen lds
    s_add_u32 s64, s32, 0
    s_and_b32 s64, s64, 3
    v_xor_b32 v22, s64, v11
    v_lshlrev_b32 v22, 6, v22
    v_lshl_add_u32 v22, v13, 8, v22
    v_lshl_add_u32 v22, v9, 5, v22
    v_lshl_add_u32 v22, v12, 3, v22
    s_lshl_b32 s64, s42, 10
    v_add_u32 v22, s64, v22
    s_lshl_b32 s64, s42, 11
    s_sub_u32 s64, 1024, s64
    v_add_u32 v26, s64, v22
    s_add_u32 s64, s32, 1
    s_and_b32 s64, s64, 3
    v_xor_b32 v23, s64, v11
    v_lshlrev_b32 v23, 6, v23
    v_lshl_add_u32 v23, v13, 8, v23
    v_lshl_add_u32 v23, v9, 5, v23
    v_lshl_add_u32 v23, v12, 3, v23
    s_lshl_b32 s64, s42, 10
    v_add_u32 v23, s64, v23
    s_lshl_b32 s64, s42, 11
    s_sub_u32 s64, 1024, s64
    v_add_u32 v27, s64, v23
    s_add_u32 s64, s32, 2
    s_and_b32 s64, s64, 3
    v_xor_b32 v24, s64, v11
    v_lshlrev_b32 v24, 6, v24
    v_lshl_add_u32 v24, v13, 8, v24
    v_lshl_add_u32 v24, v9, 5, v24
    v_lshl_add_u32 v24, v12, 3, v24
    s_lshl_b32 s64, s42, 10
    v_add_u32 v24, s64, v24
    s_lshl_b32 s64, s42, 11
    s_sub_u32 s64, 1024, s64
    v_add_u32 v28, s64, v24
    s_add_u32 s64, s32, 3
    s_and_b32 s64, s64, 3
    v_xor_b32 v25, s64, v11
    v_lshlrev_b32 v25, 6, v25
    v_lshl_add_u32 v25, v13, 8, v25
    v_lshl_add_u32 v25, v9, 5, v25
    v_lshl_add_u32 v25, v12, 3, v25
    s_lshl_b32 s64, s42, 10
    v_add_u32 v25, s64, v25
    s_lshl_b32 s64, s42, 11
    s_sub_u32 s64, 1024, s64
    v_add_u32 v29, s64, v25
    v_mov_b32 v64, 0
    v_mov_b32 v65, 0
    v_mov_b32 v66, 0
    v_mov_b32 v67, 0
    v_mov_b32 v68, 0
    v_mov_b32 v69, 0
    v_mov_b32 v70, 0
    v_mov_b32 v71, 0
    v_mov_b32 v72, 0
    v_mov_b32 v73, 0
    v_mov_b32 v74, 0
    v_mov_b32 v75, 0
    v_mov_b32 v76, 0
    v_mov_b32 v77, 0
    v_mov_b32 v78, 0
    v_mov_b32 v79, 0
    v_mov_b32 v80, 0
    v_mov_b32 v81, 0
    v_mov_b32 v82, 0
    v_mov_b32 v83, 0
    v_mov_b32 v84, 0
    v_mov_b32 v85, 0
    v_mov_b32 v86, 0
    v_mov_b32 v87, 0
    v_mov_b32 v88, 0
    v_mov_b32 v89, 0
    v_mov_b32 v90, 0
    v_mov_b32 v91, 0
    v_mov_b32 v92, 0
    v_mov_b32 v93, 0
    v_mov_b32 v94, 0
    v_mov_b32 v95, 0
    v_mov_b32 v96, 0
    v_mov_b32 v97, 0
    v_mov_b32 v98, 0
    v_mov_b32 v99, 0
    v_mov_b32 v100, 0
    v_mov_b32 v101, 0
    v_mov_b32 v102, 0
    v_mov_b32 v103, 0
    v_mov_b32 v104, 0
    v_mov_b32 v105, 0
    v_mov_b32 v106, 0
    v_mov_b32 v107, 0
    v_mov_b32 v108, 0
    v_mov_b32 v109, 0
    v_mov_b32 v110, 0
    v_mov_b32 v111, 0
    v_mov_b32 v112, 0
    v_mov_b32 v113, 0
    v_mov_b32 v114, 0
    v_mov_b32 v115, 0
    v_mov_b32 v116, 0
    v_mov_b32 v117, 0
    v_mov_b32 v118, 0
    v_mov_b32 v119, 0
    v_mov_b32 v120, 0
    v_mov_b32 v121, 0
    v_mov_b32 v122, 0
    v_mov_b32 v123, 0
    v_mov_b32 v124, 0
    v_mov_b32 v125, 0
    v_mov_b32 v126, 0
    v_mov_b32 v127, 0
    v_lshrrev_b32 v3, 4, v1
    v_and_b32 v4, 15, v1
    v_lshlrev_b32 v21, 2, v3
    v_xor_b32 v21, v21, v4
    v_lshlrev_b32 v21, 4, v21
    v_mul_u32_u24 v6, 4352, v3
    v_add_u32 v21, v21, v6
    s_mul_i32 s64, s32, 17408
    s_lshl_b32 s65, s41, 8
    s_add_u32 s64, s64, s65
    s_add_u32 s64, s64, 131072
    v_add_u32 v21, s64, v21
    s_waitcnt vmcnt(0)
    s_barrier
    s_mov_b32 s64, 65536
    s_cmp_eq_u32 s32, 0
    s_cbranch_scc0 L_pi_s2
    v_lshlrev_b32 v32, 6, v1
    v_add_u32 v32, s64, v32
    v_add_u32 v37, 192, v1
    v_min_u32 v37, 223, v37
    v_lshlrev_b32 v37, 6, v37
    v_add_u32 v37, s64, v37
    buffer_load_dword v33, v32, s[56:59], 0 offen sc1
    s_mov_b32 s67, 4096
    buffer_load_dword v34, v32, s[56:59], s67 offen sc1
    s_mov_b32 s67, 8192
    buffer_load_dword v35, v32, s[56:59], s67 offen sc1
    buffer_load_dword v36, v37, s[56:59], 0 offen sc1
L_pi_s2:
    ds_read_b64_tr_b16 v[164:165], v16 offset:0
    ds_read_b64_tr_b16 v[166:167], v17 offset:0
    ds_read_b64_tr_b16 v[168:169], v16 offset:8192
    ds_read_b64_tr_b16 v[170:171], v17 offset:8192
    ds_read_b64_tr_b16 v[172:173], v16 offset:16384
    ds_read_b64_tr_b16 v[174:175], v17 offset:16384
    ds_read_b64_tr_b16 v[176:177], v16 offset:24576
    ds_read_b64_tr_b16 v[178:179], v17 offset:24576
    ds_read_b64_tr_b16 v[180:181], v16 offset:32768
    ds_read_b64_tr_b16 v[182:183], v17 offset:32768
    ds_read_b64_tr_b16 v[184:185], v16 offset:40960
    ds_read_b64_tr_b16 v[186:187], v17 offset:40960
    ds_read_b64_tr_b16 v[188:189], v16 offset:49152
    ds_read_b64_tr_b16 v[190:191], v17 offset:49152
    ds_read_b64_tr_b16 v[192:193], v16 offset:57344
    ds_read_b64_tr_b16 v[194:195], v17 offset:57344
    ds_read_b64_tr_b16 v[196:197], v18 offset:0
    ds_read_b64_tr_b16 v[198:199], v19 offset:0
    v_mov_b32 v5, v16
    v_mov_b32 v6, v17
    s_waitcnt lgkmcnt(0)
    s_and_b32 s64, s2, 7
    s_mul_i32 s64, s64, 28
    s_lshr_b32 s65, s2, 3
    s_add_u32 s64, s64, s65
    s_mul_i32 s79, s64, 9363
    s_lshr_b32 s79, s79, 16
    s_mul_i32 s65, s79, 7
    s_sub_u32 s78, s64, s65
    s_and_b32 s76, s32, 3
    s_lshr_b32 s77, s32, 2
    s_lshr_b32 s50, s76, 1
    s_mov_b32 s44, s24
    s_mov_b32 s45, s25
    s_mov_b32 s46, 1605632
    s_mov_b32 s47, 0x20000
    s_and_b32 s64, s79, 3
    s_mul_i32 s64, s64, 7
    s_lshl_b32 s65, s78, 2
    s_add_u32 s64, s64, s65
    s_sub_u32 s65, s64, 28
    s_cmp_ge_u32 s64, 28
    s_cselect_b32 s48, s65, s64
    v_lshrrev_b32 v3, 3, v1
    v_and_b32 v4, 7, v1
    v_bfe_u32 v20, v3, 1, 1
    v_lshlrev_b32 v20, 2, v20
    v_xor_b32 v20, v20, v4
    v_lshlrev_b32 v20, 4, v20
    s_mul_i32 s64, s76, 448
    s_lshl_b32 s65, s77, 3
    s_add_u32 s64, s64, s65
    v_add_u32 v3, s64, v3
    s_movk_i32 s65, 896
    v_mul_lo_u32 v3, v3, s65
    v_add_u32 v20, v20, v3
    s_lshl_b32 s65, s78, 7
    v_add_u32 v20, s65, v20
    s_lshl_b32 s49, s76, 11
    s_lshl_b32 s64, s77, 10
    s_add_u32 s49, s49, s64
    v_xor_b32 v14, s50, v9
    v_lshlrev_b32 v14, 1, v14
    v_and_b32 v15, 1, v12
    v_add_u32 v14, v14, v15
    s_lshl_b32 s64, s77, 2
    v_add_u32 v14, s64, v14
    v_bfe_u32 v15, v11, 1, 1
    v_lshlrev_b32 v15, 2, v15
    v_xor_b32 v14, v14, v15
    v_lshlrev_b32 v14, 4, v14
    v_lshrrev_b32 v15, 1, v12
    v_lshl_add_u32 v14, v15, 3, v14
    v_lshl_add_u32 v14, v13, 7, v14
    s_lshl_b32 s64, s76, 11
    v_add_u32 v14, s64, v14
    v_add_u32 v15, 0x10000, v14
    v_add_u32 v18, 0x20000, v14
    v_mov_b32 v16, v5
    v_mov_b32 v17, v6
    v_add_u32 v19, 0x24000, v17
    v_add_u32 v13, 0x24000, v16
    v_add_u32 v16, 0x14000, v16
    v_add_u32 v17, 0x14000, v17
    v_mov_b32 v12, v250
    s_waitcnt vmcnt(0)
    s_cmp_eq_u32 s32, 0
    s_cbranch_scc0 L_pc_s2_bar
    s_mov_b32 s66, 0
L_pc_s2:
    v_xor_b32 v33, s33, v33
    v_xor_b32 v34, s33, v34
    v_or_b32 v33, v33, v34
    v_xor_b32 v35, s33, v35
    v_or_b32 v33, v33, v35
    v_xor_b32 v36, s33, v36
    v_or_b32 v33, v33, v36
    v_cmp_ne_u32 vcc, 0, v33
    s_cbranch_vccz L_pc_s2_bar
    s_add_u32 s66, s66, 1
    s_cmp_gt_u32 s66, 30000
    s_cbranch_scc1 L_pc_s2_bar
    buffer_load_dword v33, v32, s[56:59], 0 offen sc1
    s_mov_b32 s67, 4096
    buffer_load_dword v34, v32, s[56:59], s67 offen sc1
    s_mov_b32 s67, 8192
    buffer_load_dword v35, v32, s[56:59], s67 offen sc1
    buffer_load_dword v36, v37, s[56:59], 0 offen sc1
    s_waitcnt vmcnt(0)
    s_branch L_pc_s2
L_pc_s2_bar:
    s_barrier
    s_add_u32 m0, s43, 0
    s_mov_b32 s67, 0
    buffer_load_dwordx4 v21, s[56:59], s67 offen lds
    s_add_u32 m0, s43, 8192
    s_mov_b32 s67, 139264
    buffer_load_dwordx4 v21, s[56:59], s67 offen lds
    s_add_u32 m0, s43, 16384
    s_mov_b32 s67, 278528
    buffer_load_dwordx4 v21, s[56:59], s67 offen lds
    s_add_u32 m0, s43, 24576
    s_mov_b32 s67, 417792
    buffer_load_dwordx4 v21, s[56:59], s67 offen lds
    s_waitcnt vmcnt(2)
    s_barrier
    ds_read_b64_tr_b16 v[32:33], v22 offset:0
    ds_read_b64_tr_b16 v[34:35], v26 offset:0
    ds_read_b64_tr_b16 v[36:37], v23 offset:0
    ds_read_b64_tr_b16 v[38:39], v27 offset:0
    ds_read_b64_tr_b16 v[40:41], v24 offset:0
    ds_read_b64_tr_b16 v[42:43], v28 offset:0
    ds_read_b64_tr_b16 v[44:45], v25 offset:0
    ds_read_b64_tr_b16 v[46:47], v29 offset:0
    ds_read_b64_tr_b16 v[48:49], v22 offset:4096
    ds_read_b64_tr_b16 v[50:51], v26 offset:4096
    ds_read_b64_tr_b16 v[52:53], v23 offset:4096
    ds_read_b64_tr_b16 v[54:55], v27 offset:4096
    ds_read_b64_tr_b16 v[56:57], v24 offset:4096
    ds_read_b64_tr_b16 v[58:59], v28 offset:4096
    ds_read_b64_tr_b16 v[60:61], v25 offset:4096
    ds_read_b64_tr_b16 v[62:63], v29 offset:4096
    s_waitcnt lgkmcnt(8)
    v_mfma_f32_32x32x16_bf16 v[64:79], v[128:131], v[32:35], v[64:79]
    ds_read_b64_tr_b16 v[240:241], v22 offset:8192
    ds_read_b64_tr_b16 v[242:243], v26 offset:8192
    v_mfma_f32_32x32x16_bf16 v[80:95], v[128:131], v[36:39], v[80:95]
    ds_read_b64_tr_b16 v[244:245], v23 offset:8192
    ds_read_b64_tr_b16 v[246:247], v27 offset:8192
    s_add_u32 m0, s43, 32768
    s_mov_b32 s67, 557056
    buffer_load_dwordx4 v21, s[56:59], s67 offen lds
    v_mfma_f32_32x32x16_bf16 v[96:111], v[128:131], v[40:43], v[96:111]
    ds_read_b64_tr_b16 v[248:249], v24 offset:8192
    ds_read_b64_tr_b16 v[250:251], v28 offset:8192
    s_add_u32 m0, s43, 40960
    s_mov_b32 s67, 696320
    buffer_load_dwordx4 v21, s[56:59], s67 offen lds
    v_mfma_f32_32x32x16_bf16 v[112:127], v[128:131], v[44:47], v[112:127]
    ds_read_b64_tr_b16 v[252:253], v25 offset:8192
    ds_read_b64_tr_b16 v[254:255], v29 offset:8192
    s_add_u32 m0, s43, 49152
    s_mov_b32 s67, 835584
    buffer_load_dwordx4 v21, s[56:59], s67 offen lds
    s_waitcnt lgkmcnt(8)
    v_mfma_f32_32x32x16_bf16 v[64:79], v[132:135], v[48:51], v[64:79]
    ds_read_b64_tr_b16 v[32:33], v22 offset:12288
    ds_read_b64_tr_b16 v[34:35], v26 offset:12288
    v_mfma_f32_32x32x16_bf16 v[80:95], v[132:135], v[52:55], v[80:95]
    ds_read_b64_tr_b16 v[36:37], v23 offset:12288
    ds_read_b64_tr_b16 v[38:39], v27 offset:12288
    s_add_u32 m0, s43, 57344
    s_mov_b32 s67, 974848
    buffer_load_dwordx4 v21, s[56:59], s67 offen lds
    v_mfma_f32_32x32x16_bf16 v[96:111], v[132:135], v[56:59], v[96:111]
    ds_read_b64_tr_b16 v[40:41], v24 offset:12288
    ds_read_b64_tr_b16 v[42:43], v28 offset:12288
    s_add_u32 m0, s43, 65536
    s_mov_b32 s67, 1114112
    buffer_load_dwordx4 v21, s[56:59], s67 offen lds
    v_mfma_f32_32x32x16_bf16 v[112:127], v[132:135], v[60:63], v[112:127]
    ds_read_b64_tr_b16 v[44:45], v25 offset:12288
    ds_read_b64_tr_b16 v[46:47], v29 offset:12288
    s_add_u32 m0, s43, 73728
    s_mov_b32 s67, 1253376
    buffer_load_dwordx4 v21, s[56:59], s67 offen lds
    s_waitcnt lgkmcnt(8)
    s_waitcnt vmcnt(6)
    s_barrier
    v_mfma_f32_32x32x16_bf16 v[64:79], v[136:139], v[240:243], v[64:79]
    ds_read_b64_tr_b16 v[48:49], v22 offset:16384
    ds_read_b64_tr_b16 v[50:51], v26 offset:16384
    v_mfma_f32_32x32x16_bf16 v[80:95], v[136:139], v[244:247], v[80:95]
    ds_read_b64_tr_b16 v[52:53], v23 offset:16384
    ds_read_b64_tr_b16 v[54:55], v27 offset:16384
    s_add_u32 m0, s43, 81920
    s_mov_b32 s67, 1032192
    buffer_load_dwordx4 v12, s[52:55], s67 offen lds
    v_mfma_f32_32x32x16_bf16 v[96:111], v[136:139], v[248:251], v[96:111]
    ds_read_b64_tr_b16 v[56:57], v24 offset:16384
    ds_read_b64_tr_b16 v[58:59], v28 offset:16384
    s_add_u32 m0, s43, 90112
    s_mov_b32 s67, 1089536
    buffer_load_dwordx4 v12, s[52:55], s67 offen lds
    v_mfma_f32_32x32x16_bf16 v[112:127], v[136:139], v[252:255], v[112:127]
    ds_read_b64_tr_b16 v[60:61], v25 offset:16384
    ds_read_b64_tr_b16 v[62:63], v29 offset:16384
    s_add_u32 m0, s43, 98304
    s_mov_b32 s67, 1146880
    buffer_load_dwordx4 v12, s[52:55], s67 offen lds
    s_waitcnt lgkmcnt(8)
    v_mfma_f32_32x32x16_bf16 v[64:79], v[140:143], v[32:35], v[64:79]
    ds_read_b64_tr_b16 v[240:241], v22 offset:20480
    ds_read_b64_tr_b16 v[242:243], v26 offset:20480
    v_mfma_f32_32x32x16_bf16 v[80:95], v[140:143], v[36:39], v[80:95]
    ds_read_b64_tr_b16 v[244:245], v23 offset:20480
    ds_read_b64_tr_b16 v[246:247], v27 offset:20480
    s_add_u32 m0, s43, 106496
    s_mov_b32 s67, 1204224
    buffer_load_dwordx4 v12, s[52:55], s67 offen lds
    v_mfma_f32_32x32x16_bf16 v[96:111], v[140:143], v[40:43], v[96:111]
    ds_read_b64_tr_b16 v[248:249], v24 offset:20480
    ds_read_b64_tr_b16 v[250:251], v28 offset:20480
    s_add_u32 m0, s43, 114688
    s_mov_b32 s67, 1261568
    buffer_load_dwordx4 v12, s[52:55], s67 offen lds
    v_mfma_f32_32x32x16_bf16 v[112:127], v[140:143], v[44:47], v[112:127]
    ds_read_b64_tr_b16 v[252:253], v25 offset:20480
    ds_read_b64_tr_b16 v[254:255], v29 offset:20480
    s_add_u32 m0, s43, 122880
    s_mov_b32 s67, 1318912
    buffer_load_dwordx4 v12, s[52:55], s67 offen lds
    s_waitcnt lgkmcnt(8)
    v_mfma_f32_32x32x16_bf16 v[64:79], v[144:147], v[48:51], v[64:79]
    ds_read_b64_tr_b16 v[32:33], v22 offset:24576
    ds_read_b64_tr_b16 v[34:35], v26 offset:24576
    v_mfma_f32_32x32x16_bf16 v[80:95], v[144:147], v[52:55], v[80:95]
    ds_read_b64_tr_b16 v[36:37], v23 offset:24576
    ds_read_b64_tr_b16 v[38:39], v27 offset:24576
    s_add_u32 m0, s43, 131072
    s_mov_b32 s67, 1376256
    buffer_load_dwordx4 v12, s[52:55], s67 offen lds
    v_mfma_f32_32x32x16_bf16 v[96:111], v[144:147], v[56:59], v[96:111]
    ds_read_b64_tr_b16 v[40:41], v24 offset:24576
    ds_read_b64_tr_b16 v[42:43], v28 offset:24576
    s_add_u32 m0, s43, 139264
    s_mov_b32 s67, 1433600
    buffer_load_dwordx4 v12, s[52:55], s67 offen lds
    v_mfma_f32_32x32x16_bf16 v[112:127], v[144:147], v[60:63], v[112:127]
    ds_read_b64_tr_b16 v[44:45], v25 offset:24576
    ds_read_b64_tr_b16 v[46:47], v29 offset:24576
    s_add_u32 m0, s43, 147456
    s_mov_b32 s67, 1490944
    buffer_load_dwordx4 v12, s[52:55], s67 offen lds
    s_waitcnt lgkmcnt(8)
    v_mfma_f32_32x32x16_bf16 v[64:79], v[148:151], v[240:243], v[64:79]
    ds_read_b64_tr_b16 v[48:49], v22 offset:28672
    ds_read_b64_tr_b16 v[50:51], v26 offset:28672
    v_mfma_f32_32x32x16_bf16 v[80:95], v[148:151], v[244:247], v[80:95]
    ds_read_b64_tr_b16 v[52:53], v23 offset:28672
    ds_read_b64_tr_b16 v[54:55], v27 offset:28672
    s_add_u32 m0, s43, 155648
    s_mov_b32 s67, 1548288
    buffer_load_dwordx4 v12, s[52:55], s67 offen lds
    v_mfma_f32_32x32x16_bf16 v[96:111], v[148:151], v[248:251], v[96:111]
    ds_read_b64_tr_b16 v[56:57], v24 offset:28672
    ds_read_b64_tr_b16 v[58:59], v28 offset:28672
    s_add_u32 m0, s49, 0
    s_mov_b32 s67, 0
    buffer_load_dwordx4 v20, s[44:47], s67 offen lds
    v_mfma_f32_32x32x16_bf16 v[112:127], v[148:151], v[252:255], v[112:127]
    ds_read_b64_tr_b16 v[60:61], v25 offset:28672
    ds_read_b64_tr_b16 v[62:63], v29 offset:28672
    s_waitcnt lgkmcnt(8)
    s_waitcnt vmcnt(13)
    s_barrier
    v_mfma_f32_32x32x16_bf16 v[64:79], v[152:155], v[32:35], v[64:79]
    ds_read_b64_tr_b16 v[240:241], v22 offset:32768
    ds_read_b64_tr_b16 v[242:243], v26 offset:32768
    v_mfma_f32_32x32x16_bf16 v[80:95], v[152:155], v[36:39], v[80:95]
    ds_read_b64_tr_b16 v[244:245], v23 offset:32768
    ds_read_b64_tr_b16 v[246:247], v27 offset:32768
    s_add_u32 m0, s49, 8192
    s_mov_b32 s67, 14336
    buffer_load_dwordx4 v20, s[44:47], s67 offen lds
    v_mfma_f32_32x32x16_bf16 v[96:111], v[152:155], v[40:43], v[96:111]
    ds_read_b64_tr_b16 v[248:249], v24 offset:32768
    ds_read_b64_tr_b16 v[250:251], v28 offset:32768
    s_add_u32 m0, s49, 16384
    s_mov_b32 s67, 28672
    buffer_load_dwordx4 v20, s[44:47], s67 offen lds
    v_mfma_f32_32x32x16_bf16 v[112:127], v[152:155], v[44:47], v[112:127]
    ds_read_b64_tr_b16 v[252:253], v25 offset:32768
    ds_read_b64_tr_b16 v[254:255], v29 offset:32768
    s_waitcnt lgkmcnt(8)
    v_mfma_f32_32x32x16_bf16 v[64:79], v[156:159], v[48:51], v[64:79]
    ds_read_b64_tr_b16 v[32:33], v22 offset:36864
    ds_read_b64_tr_b16 v[34:35], v26 offset:36864
    v_mfma_f32_32x32x16_bf16 v[80:95], v[156:159], v[52:55], v[80:95]
    ds_read_b64_tr_b16 v[36:37], v23 offset:36864
    ds_read_b64_tr_b16 v[38:39], v27 offset:36864
    v_mfma_f32_32x32x16_bf16 v[96:111], v[156:159], v[56:59], v[96:111]
    ds_read_b64_tr_b16 v[40:41], v24 offset:36864
    ds_read_b64_tr_b16 v[42:43], v28 offset:36864
    v_mfma_f32_32x32x16_bf16 v[112:127], v[156:159], v[60:63], v[112:127]
    ds_read_b64_tr_b16 v[44:45], v25 offset:36864
    ds_read_b64_tr_b16 v[46:47], v29 offset:36864
    s_waitcnt lgkmcnt(8)
    v_mfma_f32_32x32x16_bf16 v[64:79], v[160:163], v[240:243], v[64:79]
    ds_read_b64_tr_b16 v[48:49], v22 offset:40960
    ds_read_b64_tr_b16 v[50:51], v26 offset:40960
    v_mfma_f32_32x32x16_bf16 v[80:95], v[160:163], v[244:247], v[80:95]
    ds_read_b64_tr_b16 v[52:53], v23 offset:40960
    ds_read_b64_tr_b16 v[54:55], v27 offset:40960
    v_mfma_f32_32x32x16_bf16 v[96:111], v[160:163], v[248:251], v[96:111]
    ds_read_b64_tr_b16 v[56:57], v24 offset:40960
    ds_read_b64_tr_b16 v[58:59], v28 offset:40960
    v_mfma_f32_32x32x16_bf16 v[112:127], v[160:163], v[252:255], v[112:127]
    ds_read_b64_tr_b16 v[60:61], v25 offset:40960
    ds_read_b64_tr_b16 v[62:63], v29 offset:40960
    s_waitcnt lgkmcnt(8)
    v_mfma_f32_32x32x16_bf16 v[64:79], v[164:167], v[32:35], v[64:79]
    ds_read_b64_tr_b16 v[240:241], v22 offset:45056
    ds_read_b64_tr_b16 v[242:243], v26 offset:45056
    v_mfma_f32_32x32x16_bf16 v[80:95], v[164:167], v[36:39], v[80:95]
    ds_read_b64_tr_b16 v[244:245], v23 offset:45056
    ds_read_b64_tr_b16 v[246:247], v27 offset:45056
    v_mfma_f32_32x32x16_bf16 v[96:111], v[164:167], v[40:43], v[96:111]
    ds_read_b64_tr_b16 v[248:249], v24 offset:45056
    ds_read_b64_tr_b16 v[250:251], v28 offset:45056
    v_mfma_f32_32x32x16_bf16 v[112:127], v[164:167], v[44:47], v[112:127]
    ds_read_b64_tr_b16 v[252:253], v25 offset:45056
    ds_read_b64_tr_b16 v[254:255], v29 offset:45056
    s_waitcnt lgkmcnt(8)
    s_waitcnt vmcnt(0)
    s_barrier
    v_mfma_f32_32x32x16_bf16 v[64:79], v[168:171], v[48:51], v[64:79]
    ds_read_b64_tr_b16 v[32:33], v22 offset:49152
    ds_read_b64_tr_b16 v[34:35], v26 offset:49152
    ds_read_b64_tr_b16 v[128:129], v14 offset:0
    ds_read_b64_tr_b16 v[130:131], v14 offset:512
    ds_read_b64_tr_b16 v[132:133], v14 offset:8192
    v_mfma_f32_32x32x16_bf16 v[80:95], v[168:171], v[52:55], v[80:95]
    ds_read_b64_tr_b16 v[36:37], v23 offset:49152
    ds_read_b64_tr_b16 v[38:39], v27 offset:49152
    ds_read_b64_tr_b16 v[134:135], v14 offset:8704
    ds_read_b64_tr_b16 v[136:137], v14 offset:16384
    ds_read_b64_tr_b16 v[138:139], v14 offset:16896
    s_add_u32 m0, s49, 24576
    s_mov_b32 s67, 43008
    buffer_load_dwordx4 v20, s[44:47], s67 offen lds
    v_mfma_f32_32x32x16_bf16 v[96:111], v[168:171], v[56:59], v[96:111]
    ds_read_b64_tr_b16 v[40:41], v24 offset:49152
    ds_read_b64_tr_b16 v[42:43], v28 offset:49152
    s_add_u32 m0, s49, 32768
    s_mov_b32 s67, 57344
    buffer_load_dwordx4 v20, s[44:47], s67 offen lds
    v_mfma_f32_32x32x16_bf16 v[112:127], v[168:171], v[60:63], v[112:127]
    ds_read_b64_tr_b16 v[44:45], v25 offset:49152
    ds_read_b64_tr_b16 v[46:47], v29 offset:49152
    s_waitcnt lgkmcnt(14)
    v_mfma_f32_32x32x16_bf16 v[64:79], v[172:175], v[240:243], v[64:79]
    ds_read_b64_tr_b16 v[48:49], v22 offset:53248
    ds_read_b64_tr_b16 v[50:51], v26 offset:53248
    ds_read_b64_tr_b16 v[200:201], v16 offset:0
    ds_read_b64_tr_b16 v[202:203], v17 offset:0
    ds_read_b64_tr_b16 v[204:205], v16 offset:8192
    v_mfma_f32_32x32x16_bf16 v[80:95], v[172:175], v[244:247], v[80:95]
    ds_read_b64_tr_b16 v[52:53], v23 offset:53248
    ds_read_b64_tr_b16 v[54:55], v27 offset:53248
    ds_read_b64_tr_b16 v[206:207], v17 offset:8192
    ds_read_b64_tr_b16 v[208:209], v16 offset:16384
    ds_read_b64_tr_b16 v[210:211], v17 offset:16384
    v_mfma_f32_32x32x16_bf16 v[96:111], v[172:175], v[248:251], v[96:111]
    ds_read_b64_tr_b16 v[56:57], v24 offset:53248
    ds_read_b64_tr_b16 v[58:59], v28 offset:53248
    ds_read_b64_tr_b16 v[212:213], v16 offset:24576
    ds_read_b64_tr_b16 v[214:215], v17 offset:24576
    ds_read_b64_tr_b16 v[216:217], v16 offset:32768
    v_mfma_f32_32x32x16_bf16 v[112:127], v[172:175], v[252:255], v[112:127]
    ds_read_b64_tr_b16 v[60:61], v25 offset:53248
    ds_read_b64_tr_b16 v[62:63], v29 offset:53248
    ds_read_b64_tr_b16 v[218:219], v17 offset:32768
    s_waitcnt lgkmcnt(15)
    v_mfma_f32_32x32x16_bf16 v[64:79], v[176:179], v[32:35], v[64:79]
    ds_read_b64_tr_b16 v[240:241], v22 offset:57344
    ds_read_b64_tr_b16 v[242:243], v26 offset:57344
    ds_read_b64_tr_b16 v[220:221], v16 offset:40960
    ds_read_b64_tr_b16 v[222:223], v17 offset:40960
    ds_read_b64_tr_b16 v[224:225], v16 offset:49152
    v_mfma_f32_32x32x16_bf16 v[80:95], v[176:179], v[36:39], v[80:95]
    ds_read_b64_tr_b16 v[244:245], v23 offset:57344
    ds_read_b64_tr_b16 v[246:247], v27 offset:57344
    ds_read_b64_tr_b16 v[226:227], v17 offset:49152
    ds_read_b64_tr_b16 v[228:229], v16 offset:57344
    ds_read_b64_tr_b16 v[230:231], v17 offset:57344
    v_mfma_f32_32x32x16_bf16 v[96:111], v[176:179], v[40:43], v[96:111]
    ds_read_b64_tr_b16 v[248:249], v24 offset:57344
    ds_read_b64_tr_b16 v[250:251], v28 offset:57344
    ds_read_b64_tr_b16 v[232:233], v13 offset:0
    ds_read_b64_tr_b16 v[234:235], v19 offset:0
    ds_read_b64_tr_b16 v[236:237], v13 offset:8192
    v_mfma_f32_32x32x16_bf16 v[112:127], v[176:179], v[44:47], v[112:127]
    ds_read_b64_tr_b16 v[252:253], v25 offset:57344
    ds_read_b64_tr_b16 v[254:255], v29 offset:57344
    ds_read_b64_tr_b16 v[238:239], v19 offset:8192
    s_waitcnt lgkmcnt(0)
    v_mfma_f32_32x32x16_bf16 v[64:79], v[180:183], v[48:51], v[64:79]
    ds_read_b64_tr_b16 v[32:33], v22 offset:61440
    ds_read_b64_tr_b16 v[34:35], v26 offset:61440
    v_mfma_f32_32x32x16_bf16 v[80:95], v[180:183], v[52:55], v[80:95]
    ds_read_b64_tr_b16 v[36:37], v23 offset:61440
    ds_read_b64_tr_b16 v[38:39], v27 offset:61440
    v_mfma_f32_32x32x16_bf16 v[96:111], v[180:183], v[56:59], v[96:111]
    ds_read_b64_tr_b16 v[40:41], v24 offset:61440
    ds_read_b64_tr_b16 v[42:43], v28 offset:61440
    v_mfma_f32_32x32x16_bf16 v[112:127], v[180:183], v[60:63], v[112:127]
    ds_read_b64_tr_b16 v[44:45], v25 offset:61440
    ds_read_b64_tr_b16 v[46:47], v29 offset:61440
    s_waitcnt lgkmcnt(9)
    s_waitcnt vmcnt(0)
    s_barrier
    v_add_u32 v22, 0x10000, v22
    v_add_u32 v23, 0x10000, v23
    v_add_u32 v24, 0x10000, v24
    v_add_u32 v25, 0x10000, v25
    v_add_u32 v26, 0x10000, v26
    v_add_u32 v27, 0x10000, v27
    v_add_u32 v28, 0x10000, v28
    v_add_u32 v29, 0x10000, v29
    v_mfma_f32_32x32x16_bf16 v[64:79], v[184:187], v[240:243], v[64:79]
    ds_read_b64_tr_b16 v[48:49], v22 offset:0
    ds_read_b64_tr_b16 v[50:51], v26 offset:0
    ds_read_b64_tr_b16 v[140:141], v14 offset:24576
    ds_read_b64_tr_b16 v[142:143], v14 offset:25088
    ds_read_b64_tr_b16 v[144:145], v14 offset:32768
    v_mfma_f32_32x32x16_bf16 v[80:95], v[184:187], v[244:247], v[80:95]
    ds_read_b64_tr_b16 v[52:53], v23 offset:0
    ds_read_b64_tr_b16 v[54:55], v27 offset:0
    ds_read_b64_tr_b16 v[146:147], v14 offset:33280
    s_add_u32 m0, s43, 81920
    s_mov_b32 s67, 1392640
    buffer_load_dwordx4 v21, s[56:59], s67 offen lds
    v_mfma_f32_32x32x16_bf16 v[96:111], v[184:187], v[248:251], v[96:111]
    ds_read_b64_tr_b16 v[56:57], v24 offset:0
    ds_read_b64_tr_b16 v[58:59], v28 offset:0
    s_add_u32 m0, s43, 90112
    s_mov_b32 s67, 1531904
    buffer_load_dwordx4 v21, s[56:59], s67 offen lds
    v_mfma_f32_32x32x16_bf16 v[112:127], v[184:187], v[252:255], v[112:127]
    ds_read_b64_tr_b16 v[60:61], v25 offset:0
    ds_read_b64_tr_b16 v[62:63], v29 offset:0
    s_waitcnt lgkmcnt(12)
    v_mfma_f32_32x32x16_bf16 v[64:79], v[188:191], v[32:35], v[64:79]
    ds_read_b64_tr_b16 v[240:241], v22 offset:4096
    ds_read_b64_tr_b16 v[242:243], v26 offset:4096
    v_mfma_f32_32x32x16_bf16 v[80:95], v[188:191], v[36:39], v[80:95]
    ds_read_b64_tr_b16 v[244:245], v23 offset:4096
    ds_read_b64_tr_b16 v[246:247], v27 offset:4096
    s_add_u32 m0, s43, 98304
    s_mov_b32 s67, 1671168
    buffer_load_dwordx4 v21, s[56:59], s67 offen lds
    v_mfma_f32_32x32x16_bf16 v[96:111], v[188:191], v[40:43], v[96:111]
    ds_read_b64_tr_b16 v[248:249], v24 offset:4096
    ds_read_b64_tr_b16 v[250:251], v28 offset:4096
    s_add_u32 m0, s43, 106496
    s_mov_b32 s67, 1810432
    buffer_load_dwordx4 v21, s[56:59], s67 offen lds
    v_mfma_f32_32x32x16_bf16 v[112:127], v[188:191], v[44:47], v[112:127]
    ds_read_b64_tr_b16 v[252:253], v25 offset:4096
    ds_read_b64_tr_b16 v[254:255], v29 offset:4096
    s_waitcnt lgkmcnt(8)
    v_mfma_f32_32x32x16_bf16 v[64:79], v[192:195], v[48:51], v[64:79]
    ds_read_b64_tr_b16 v[32:33], v22 offset:8192
    ds_read_b64_tr_b16 v[34:35], v26 offset:8192
    v_mfma_f32_32x32x16_bf16 v[80:95], v[192:195], v[52:55], v[80:95]
    ds_read_b64_tr_b16 v[36:37], v23 offset:8192
    ds_read_b64_tr_b16 v[38:39], v27 offset:8192
    s_add_u32 m0, s49, 0
    s_mov_b32 s67, 71680
    buffer_load_dwordx4 v20, s[44:47], s67 offen lds
    v_mfma_f32_32x32x16_bf16 v[96:111], v[192:195], v[56:59], v[96:111]
    ds_read_b64_tr_b16 v[40:41], v24 offset:8192
    ds_read_b64_tr_b16 v[42:43], v28 offset:8192
    s_add_u32 m0, s49, 8192
    s_mov_b32 s67, 86016
    buffer_load_dwordx4 v20, s[44:47], s67 offen lds
    v_mfma_f32_32x32x16_bf16 v[112:127], v[192:195], v[60:63], v[112:127]
    ds_read_b64_tr_b16 v[44:45], v25 offset:8192
    ds_read_b64_tr_b16 v[46:47], v29 offset:8192
    s_waitcnt lgkmcnt(8)
    v_mfma_f32_32x32x16_bf16 v[64:79], v[196:199], v[240:243], v[64:79]
    ds_read_b64_tr_b16 v[48:49], v22 offset:12288
    ds_read_b64_tr_b16 v[50:51], v26 offset:12288
    v_mfma_f32_32x32x16_bf16 v[80:95], v[196:199], v[244:247], v[80:95]
    ds_read_b64_tr_b16 v[52:53], v23 offset:12288
    ds_read_b64_tr_b16 v[54:55], v27 offset:12288
    s_add_u32 m0, s49, 16384
    s_mov_b32 s67, 100352
    buffer_load_dwordx4 v20, s[44:47], s67 offen lds
    v_mfma_f32_32x32x16_bf16 v[96:111], v[196:199], v[248:251], v[96:111]
    ds_read_b64_tr_b16 v[56:57], v24 offset:12288
    ds_read_b64_tr_b16 v[58:59], v28 offset:12288
    s_add_u32 m0, s49, 40960
    s_mov_b32 s67, 114688
    buffer_load_dwordx4 v20, s[44:47], s67 offen lds
    v_mfma_f32_32x32x16_bf16 v[112:127], v[196:199], v[252:255], v[112:127]
    ds_read_b64_tr_b16 v[60:61], v25 offset:12288
    ds_read_b64_tr_b16 v[62:63], v29 offset:12288
    s_waitcnt lgkmcnt(8)
    s_waitcnt vmcnt(4)
    s_barrier
    s_cmp_lt_u32 s32, 4
    s_cbranch_scc0 L_prio18
    s_setprio 2
L_prio18:
    v_mfma_f32_32x32x16_bf16 v[64:79], v[200:203], v[32:35], v[64:79]
    ds_read_b64_tr_b16 v[240:241], v22 offset:16384
    ds_read_b64_tr_b16 v[242:243], v26 offset:16384
    v_mfma_f32_32x32x16_bf16 v[80:95], v[200:203], v[36:39], v[80:95]
    ds_read_b64_tr_b16 v[244:245], v23 offset:16384
    ds_read_b64_tr_b16 v[246:247], v27 offset:16384
    s_add_u32 m0, s49, 24576
    s_mov_b32 s67, 129024
    buffer_load_dwordx4 v20, s[44:47], s67 offen lds
    v_mfma_f32_32x32x16_bf16 v[96:111], v[200:203], v[40:43], v[96:111]
    ds_read_b64_tr_b16 v[248:249], v24 offset:16384
    ds_read_b64_tr_b16 v[250:251], v28 offset:16384
    s_add_u32 m0, s49, 32768
    s_mov_b32 s67, 143360
    buffer_load_dwordx4 v20, s[44:47], s67 offen lds
    v_mfma_f32_32x32x16_bf16 v[112:127], v[200:203], v[44:47], v[112:127]
    ds_read_b64_tr_b16 v[252:253], v25 offset:16384
    ds_read_b64_tr_b16 v[254:255], v29 offset:16384
    s_waitcnt lgkmcnt(8)
    v_mfma_f32_32x32x16_bf16 v[64:79], v[204:207], v[48:51], v[64:79]
    ds_read_b64_tr_b16 v[32:33], v22 offset:20480
    ds_read_b64_tr_b16 v[34:35], v26 offset:20480
    s_lshl_b32 s64, s41, 7
    s_add_u32 s64, s64, 114688
    v_and_b32 v30, 1, v1
    v_lshl_add_u32 v30, v30, 6, s64
    v_lshlrev_b32 v31, 6, v1
    v_add_u32 v31, 116736, v31
    v_cmp_gt_u32 vcc, 32, v1
    s_nop 1
    v_cndmask_b32 v30, v30, v31, vcc
    buffer_load_dword v31, v30, s[56:59], 0 offen sc1
    v_mfma_f32_32x32x16_bf16 v[80:95], v[204:207], v[52:55], v[80:95]
    ds_read_b64_tr_b16 v[36:37], v23 offset:20480
    ds_read_b64_tr_b16 v[38:39], v27 offset:20480
    s_add_u32 m0, s49, 49152
    s_mov_b32 s67, 157696
    buffer_load_dwordx4 v20, s[44:47], s67 offen lds
    v_mfma_f32_32x32x16_bf16 v[96:111], v[204:207], v[56:59], v[96:111]
    ds_read_b64_tr_b16 v[40:41], v24 offset:20480
    ds_read_b64_tr_b16 v[42:43], v28 offset:20480
    s_add_u32 m0, s49, 57344
    s_mov_b32 s67, 172032
    buffer_load_dwordx4 v20, s[44:47], s67 offen lds
    v_mfma_f32_32x32x16_bf16 v[112:127], v[204:207], v[60:63], v[112:127]
    ds_read_b64_tr_b16 v[44:45], v25 offset:20480
    ds_read_b64_tr_b16 v[46:47], v29 offset:20480
    s_waitcnt lgkmcnt(8)
    v_mfma_f32_32x32x16_bf16 v[64:79], v[208:211], v[240:243], v[64:79]
    ds_read_b64_tr_b16 v[48:49], v22 offset:24576
    ds_read_b64_tr_b16 v[50:51], v26 offset:24576
    v_mfma_f32_32x32x16_bf16 v[80:95], v[208:211], v[244:247], v[80:95]
    ds_read_b64_tr_b16 v[52:53], v23 offset:24576
    ds_read_b64_tr_b16 v[54:55], v27 offset:24576
    s_add_u32 m0, s49, 65536
    s_mov_b32 s67, 186368
    buffer_load_dwordx4 v20, s[44:47], s67 offen lds
    v_mfma_f32_32x32x16_bf16 v[96:111], v[208:211], v[248:251], v[96:111]
    ds_read_b64_tr_b16 v[56:57], v24 offset:24576
    ds_read_b64_tr_b16 v[58:59], v28 offset:24576
    s_add_u32 m0, s49, 114688
    s_mov_b32 s67, 200704
    buffer_load_dwordx4 v20, s[44:47], s67 offen lds
    v_mfma_f32_32x32x16_bf16 v[112:127], v[208:211], v[252:255], v[112:127]
    ds_read_b64_tr_b16 v[60:61], v25 offset:24576
    ds_read_b64_tr_b16 v[62:63], v29 offset:24576
    s_waitcnt lgkmcnt(8)
    v_mfma_f32_32x32x16_bf16 v[64:79], v[212:215], v[32:35], v[64:79]
    ds_read_b64_tr_b16 v[240:241], v22 offset:28672
    ds_read_b64_tr_b16 v[242:243], v26 offset:28672
    v_mfma_f32_32x32x16_bf16 v[80:95], v[212:215], v[36:39], v[80:95]
    ds_read_b64_tr_b16 v[244:245], v23 offset:28672
    ds_read_b64_tr_b16 v[246:247], v27 offset:28672
    s_add_u32 m0, s49, 122880
    s_mov_b32 s67, 215040
    buffer_load_dwordx4 v20, s[44:47], s67 offen lds
    v_mfma_f32_32x32x16_bf16 v[96:111], v[212:215], v[40:43], v[96:111]
    ds_read_b64_tr_b16 v[248:249], v24 offset:28672
    ds_read_b64_tr_b16 v[250:251], v28 offset:28672
    s_add_u32 m0, s49, 131072
    s_mov_b32 s67, 229376
    buffer_load_dwordx4 v20, s[44:47], s67 offen lds
    v_mfma_f32_32x32x16_bf16 v[112:127], v[212:215], v[44:47], v[112:127]
    ds_read_b64_tr_b16 v[252:253], v25 offset:28672
    ds_read_b64_tr_b16 v[254:255], v29 offset:28672
    s_waitcnt lgkmcnt(8)
    v_mfma_f32_32x32x16_bf16 v[64:79], v[216:219], v[48:51], v[64:79]
    ds_read_b64_tr_b16 v[32:33], v22 offset:32768
    ds_read_b64_tr_b16 v[34:35], v26 offset:32768
    v_mfma_f32_32x32x16_bf16 v[80:95], v[216:219], v[52:55], v[80:95]
    ds_read_b64_tr_b16 v[36:37], v23 offset:32768
    ds_read_b64_tr_b16 v[38:39], v27 offset:32768
    s_add_u32 m0, s49, 139264
    s_mov_b32 s67, 243712
    buffer_load_dwordx4 v20, s[44:47], s67 offen lds
    v_mfma_f32_32x32x16_bf16 v[96:111], v[216:219], v[56:59], v[96:111]
    ds_read_b64_tr_b16 v[40:41], v24 offset:32768
    ds_read_b64_tr_b16 v[42:43], v28 offset:32768
    s_add_u32 m0, s49, 147456
    s_mov_b32 s67, 258048
    buffer_load_dwordx4 v20, s[44:47], s67 offen lds
    v_mfma_f32_32x32x16_bf16 v[112:127], v[216:219], v[60:63], v[112:127]
    ds_read_b64_tr_b16 v[44:45], v25 offset:32768
    ds_read_b64_tr_b16 v[46:47], v29 offset:32768
    s_waitcnt lgkmcnt(8)
    v_mfma_f32_32x32x16_bf16 v[64:79], v[220:223], v[240:243], v[64:79]
    ds_read_b64_tr_b16 v[48:49], v22 offset:36864
    ds_read_b64_tr_b16 v[50:51], v26 offset:36864
    s_waitcnt vmcnt(8)
    s_mov_b32 s66, 0
L_f3_chk:
    v_cmp_ne_u32 vcc, s33, v31
    s_cbranch_vccz L_f3_ok
    s_add_u32 s66, s66, 1
    s_cmp_gt_u32 s66, 30000
    s_cbranch_scc1 L_f3_ok
    buffer_load_dword v31, v30, s[56:59], 0 offen sc1
    s_waitcnt vmcnt(0)
    s_branch L_f3_chk
L_f3_ok:
    v_and_b32 v30, 31, v1
    v_lshlrev_b32 v30, 3, v30
    s_add_u32 s64, s32, 0
    s_and_b32 s64, s64, 3
    s_lshl_b32 s65, s41, 2
    s_add_u32 s64, s64, s65
    s_lshl_b32 s64, s64, 8
    s_add_u32 s64, s64, 3964928
    buffer_load_dwordx2 v[4:5], v30, s[56:59], s64 offen
    s_add_u32 s64, s32, 1
    s_and_b32 s64, s64, 3
    s_lshl_b32 s65, s41, 2
    s_add_u32 s64, s64, s65
    s_lshl_b32 s64, s64, 8
    s_add_u32 s64, s64, 3964928
    buffer_load_dwordx2 v[6:7], v30, s[56:59], s64 offen
    s_add_u32 s64, s32, 2
    s_and_b32 s64, s64, 3
    s_lshl_b32 s65, s41, 2
    s_add_u32 s64, s64, s65
    s_lshl_b32 s64, s64, 8
    s_add_u32 s64, s64, 3964928
    buffer_load_dwordx2 v[8:9], v30, s[56:59], s64 offen
    s_add_u32 s64, s32, 3
    s_and_b32 s64, s64, 3
    s_lshl_b32 s65, s41, 2
    s_add_u32 s64, s64, s65
    s_lshl_b32 s64, s64, 8
    s_add_u32 s64, s64, 3964928
    buffer_load_dwordx2 v[10:11], v30, s[56:59], s64 offen
    v_mfma_f32_32x32x16_bf16 v[80:95], v[220:223], v[244:247], v[80:95]
    ds_read_b64_tr_b16 v[52:53], v23 offset:36864
    ds_read_b64_tr_b16 v[54:55], v27 offset:36864
    s_add_u32 m0, s49, 155648
    s_mov_b32 s67, 272384
    buffer_load_dwordx4 v20, s[44:47], s67 offen lds
    v_mfma_f32_32x32x16_bf16 v[96:111], v[220:223], v[248:251], v[96:111]
    ds_read_b64_tr_b16 v[56:57], v24 offset:36864
    ds_read_b64_tr_b16 v[58:59], v28 offset:36864
    v_mfma_f32_32x32x16_bf16 v[112:127], v[220:223], v[252:255], v[112:127]
    ds_read_b64_tr_b16 v[60:61], v25 offset:36864
    ds_read_b64_tr_b16 v[62:63], v29 offset:36864
    s_waitcnt lgkmcnt(8)
    v_mfma_f32_32x32x16_bf16 v[64:79], v[224:227], v[32:35], v[64:79]
    ds_read_b64_tr_b16 v[240:241], v22 offset:40960
    ds_read_b64_tr_b16 v[242:243], v26 offset:40960
    v_mfma_f32_32x32x16_bf16 v[80:95], v[224:227], v[36:39], v[80:95]
    ds_read_b64_tr_b16 v[244:245], v23 offset:40960
    ds_read_b64_tr_b16 v[246:247], v27 offset:40960
    v_mfma_f32_32x32x16_bf16 v[96:111], v[224:227], v[40:43], v[96:111]
    ds_read_b64_tr_b16 v[248:249], v24 offset:40960
    ds_read_b64_tr_b16 v[250:251], v28 offset:40960
    v_mfma_f32_32x32x16_bf16 v[112:127], v[224:227], v[44:47], v[112:127]
    ds_read_b64_tr_b16 v[252:253], v25 offset:40960
    ds_read_b64_tr_b16 v[254:255], v29 offset:40960
    s_waitcnt lgkmcnt(8)
    v_mfma_f32_32x32x16_bf16 v[64:79], v[228:231], v[48:51], v[64:79]
    ds_read_b64_tr_b16 v[32:33], v22 offset:45056
    ds_read_b64_tr_b16 v[34:35], v26 offset:45056
    v_mfma_f32_32x32x16_bf16 v[80:95], v[228:231], v[52:55], v[80:95]
    ds_read_b64_tr_b16 v[36:37], v23 offset:45056
    ds_read_b64_tr_b16 v[38:39], v27 offset:45056
    v_mfma_f32_32x32x16_bf16 v[96:111], v[228:231], v[56:59], v[96:111]
    ds_read_b64_tr_b16 v[40:41], v24 offset:45056
    ds_read_b64_tr_b16 v[42:43], v28 offset:45056
    v_mfma_f32_32x32x16_bf16 v[112:127], v[228:231], v[60:63], v[112:127]
    ds_read_b64_tr_b16 v[44:45], v25 offset:45056
    ds_read_b64_tr_b16 v[46:47], v29 offset:45056
    s_waitcnt lgkmcnt(8)
    v_mfma_f32_32x32x16_bf16 v[64:79], v[232:235], v[240:243], v[64:79]
    v_mfma_f32_32x32x16_bf16 v[80:95], v[232:235], v[244:247], v[80:95]
    v_mfma_f32_32x32x16_bf16 v[96:111], v[232:235], v[248:251], v[96:111]
    v_lshrrev_b32 v2, 5, v1
    v_lshlrev_b32 v2, 5, v2
    s_lshl_b32 s64, s40, 9
    s_lshl_b32 s65, s32, 6
    s_add_u32 s64, s64, s65
    s_add_u32 s64, s64, 32768
    v_add_u32 v2, s64, v2
    v_add_u32 v3, 7168, v2
    buffer_load_dwordx4 v[48:51], v2, s[56:59], 0 offen offset:0
    buffer_load_dwordx4 v[56:59], v3, s[56:59], 0 offen offset:0
    buffer_load_dwordx4 v[52:55], v2, s[56:59], 0 offen offset:16
    buffer_load_dwordx4 v[60:63], v3, s[56:59], 0 offen offset:16
    v_mfma_f32_32x32x16_bf16 v[112:127], v[232:235], v[252:255], v[112:127]
    s_waitcnt lgkmcnt(0)
    v_mfma_f32_32x32x16_bf16 v[64:79], v[236:239], v[32:35], v[64:79]
    v_mfma_f32_32x32x16_bf16 v[80:95], v[236:239], v[36:39], v[80:95]
    v_mfma_f32_32x32x16_bf16 v[96:111], v[236:239], v[40:43], v[96:111]
    v_mfma_f32_32x32x16_bf16 v[112:127], v[236:239], v[44:47], v[112:127]
    s_waitcnt vmcnt(0)
    v_mov_b32 v32, v4
    v_mul_f32 v34, 0xbfb8aa3b, v5
    v_mul_f32 v35, v5, v5
    v_mov_b32 v36, v6
    v_mul_f32 v38, 0xbfb8aa3b, v7
    v_mul_f32 v39, v7, v7
    v_mov_b32 v40, v8
    v_mul_f32 v42, 0xbfb8aa3b, v9
    v_mul_f32 v43, v9, v9
    v_mov_b32 v44, v10
    v_mul_f32 v46, 0xbfb8aa3b, v11
    v_mul_f32 v47, v11, v11
    v_lshlrev_b32 v6, 4, v1
    v_add_u32 v6, 4194304, v6
    s_add_u32 s64, s32, 0
    s_and_b32 s64, s64, 3
    s_lshl_b32 s65, s41, 2
    s_add_u32 s64, s64, s65
    s_mul_i32 s64, s64, 112
    s_lshl_b32 s65, s40, 3
    s_add_u32 s64, s64, s65
    s_add_u32 s64, s64, s32
    s_lshl_b32 s72, s64, 10
    s_add_u32 s64, s32, 1
    s_and_b32 s64, s64, 3
    s_lshl_b32 s65, s41, 2
    s_add_u32 s64, s64, s65
    s_mul_i32 s64, s64, 112
    s_lshl_b32 s65, s40, 3
    s_add_u32 s64, s64, s65
    s_add_u32 s64, s64, s32
    s_lshl_b32 s73, s64, 10
    s_add_u32 s64, s32, 2
    s_and_b32 s64, s64, 3
    s_lshl_b32 s65, s41, 2
    s_add_u32 s64, s64, s65
    s_mul_i32 s64, s64, 112
    s_lshl_b32 s65, s40, 3
    s_add_u32 s64, s64, s65
    s_add_u32 s64, s64, s32
    s_lshl_b32 s74, s64, 10
    s_add_u32 s64, s32, 3
    s_and_b32 s64, s64, 3
    s_lshl_b32 s65, s41, 2
    s_add_u32 s64, s64, s65
    s_mul_i32 s64, s64, 112
    s_lshl_b32 s65, s40, 3
    s_add_u32 s64, s64, s65
    s_add_u32 s64, s64, s32
    s_lshl_b32 s75, s64, 10
    v_fma_f32 v64, -v32, v48, v64
    v_fma_f32 v72, -v32, v56, v72
    v_fma_f32 v65, -v32, v49, v65
    v_fma_f32 v73, -v32, v57, v73
    v_fma_f32 v66, -v32, v50, v66
    v_fma_f32 v74, -v32, v58, v74
    v_fma_f32 v67, -v32, v51, v67
    v_fma_f32 v75, -v32, v59, v75
    v_fma_f32 v68, -v32, v52, v68
    v_fma_f32 v76, -v32, v60, v76
    v_fma_f32 v69, -v32, v53, v69
    v_fma_f32 v77, -v32, v61, v77
    v_fma_f32 v70, -v32, v54, v70
    v_fma_f32 v78, -v32, v62, v78
    v_fma_f32 v71, -v32, v55, v71
    v_fma_f32 v79, -v32, v63, v79
    v_mul_f32 v240, v64, v34
    v_mul_f32 v64, v64, v72
    v_exp_f32 v240, v240
    v_mul_f32 v241, v65, v34
    v_mul_f32 v65, v65, v73
    v_exp_f32 v241, v241
    v_mul_f32 v242, v66, v34
    v_mul_f32 v66, v66, v74
    v_exp_f32 v242, v242
    v_mul_f32 v243, v67, v34
    v_mul_f32 v67, v67, v75
    v_exp_f32 v243, v243
    v_mul_f32 v244, v68, v34
    v_mul_f32 v68, v68, v76
    v_exp_f32 v244, v244
    v_mul_f32 v245, v69, v34
    v_mul_f32 v69, v69, v77
    v_exp_f32 v245, v245
    v_mul_f32 v246, v70, v34
    v_mul_f32 v70, v70, v78
    v_exp_f32 v246, v246
    v_mul_f32 v247, v71, v34
    v_mul_f32 v71, v71, v79
    v_exp_f32 v247, v247
    v_mul_f32 v64, v64, v35
    v_add_f32 v240, 1.0, v240
    v_rcp_f32 v240, v240
    v_mul_f32 v65, v65, v35
    v_add_f32 v241, 1.0, v241
    v_rcp_f32 v241, v241
    v_mul_f32 v66, v66, v35
    v_add_f32 v242, 1.0, v242
    v_rcp_f32 v242, v242
    v_mul_f32 v67, v67, v35
    v_add_f32 v243, 1.0, v243
    v_rcp_f32 v243, v243
    v_mul_f32 v68, v68, v35
    v_add_f32 v244, 1.0, v244
    v_rcp_f32 v244, v244
    v_mul_f32 v69, v69, v35
    v_add_f32 v245, 1.0, v245
    v_rcp_f32 v245, v245
    v_mul_f32 v70, v70, v35
    v_add_f32 v246, 1.0, v246
    v_rcp_f32 v246, v246
    v_mul_f32 v71, v71, v35
    v_add_f32 v247, 1.0, v247
    v_rcp_f32 v247, v247
    v_mul_f32 v64, v64, v240
    v_mul_f32 v65, v65, v241
    v_cvt_pk_bf16_f32 v24, v64, v65
    v_mul_f32 v66, v66, v242
    v_mul_f32 v67, v67, v243
    v_cvt_pk_bf16_f32 v25, v66, v67
    v_mul_f32 v68, v68, v244
    v_mul_f32 v69, v69, v245
    v_cvt_pk_bf16_f32 v26, v68, v69
    v_mul_f32 v70, v70, v246
    v_mul_f32 v71, v71, v247
    v_cvt_pk_bf16_f32 v27, v70, v71
    buffer_store_dwordx4 v[24:27], v6, s[56:59], s72 offen sc1
    v_fma_f32 v80, -v36, v48, v80
    v_fma_f32 v88, -v36, v56, v88
    v_fma_f32 v81, -v36, v49, v81
    v_fma_f32 v89, -v36, v57, v89
    v_fma_f32 v82, -v36, v50, v82
    v_fma_f32 v90, -v36, v58, v90
    v_fma_f32 v83, -v36, v51, v83
    v_fma_f32 v91, -v36, v59, v91
    v_fma_f32 v84, -v36, v52, v84
    v_fma_f32 v92, -v36, v60, v92
    v_fma_f32 v85, -v36, v53, v85
    v_fma_f32 v93, -v36, v61, v93
    v_fma_f32 v86, -v36, v54, v86
    v_fma_f32 v94, -v36, v62, v94
    v_fma_f32 v87, -v36, v55, v87
    v_fma_f32 v95, -v36, v63, v95
    v_mul_f32 v248, v80, v38
    v_mul_f32 v80, v80, v88
    v_exp_f32 v248, v248
    v_mul_f32 v249, v81, v38
    v_mul_f32 v81, v81, v89
    v_exp_f32 v249, v249
    v_mul_f32 v250, v82, v38
    v_mul_f32 v82, v82, v90
    v_exp_f32 v250, v250
    v_mul_f32 v251, v83, v38
    v_mul_f32 v83, v83, v91
    v_exp_f32 v251, v251
    v_mul_f32 v252, v84, v38
    v_mul_f32 v84, v84, v92
    v_exp_f32 v252, v252
    v_mul_f32 v253, v85, v38
    v_mul_f32 v85, v85, v93
    v_exp_f32 v253, v253
    v_mul_f32 v254, v86, v38
    v_mul_f32 v86, v86, v94
    v_exp_f32 v254, v254
    v_mul_f32 v255, v87, v38
    v_mul_f32 v87, v87, v95
    v_exp_f32 v255, v255
    v_mul_f32 v80, v80, v39
    v_add_f32 v248, 1.0, v248
    v_rcp_f32 v248, v248
    v_mul_f32 v81, v81, v39
    v_add_f32 v249, 1.0, v249
    v_rcp_f32 v249, v249
    v_mul_f32 v82, v82, v39
    v_add_f32 v250, 1.0, v250
    v_rcp_f32 v250, v250
    v_mul_f32 v83, v83, v39
    v_add_f32 v251, 1.0, v251
    v_rcp_f32 v251, v251
    v_mul_f32 v84, v84, v39
    v_add_f32 v252, 1.0, v252
    v_rcp_f32 v252, v252
    v_mul_f32 v85, v85, v39
    v_add_f32 v253, 1.0, v253
    v_rcp_f32 v253, v253
    v_mul_f32 v86, v86, v39
    v_add_f32 v254, 1.0, v254
    v_rcp_f32 v254, v254
    v_mul_f32 v87, v87, v39
    v_add_f32 v255, 1.0, v255
    v_rcp_f32 v255, v255
    v_mul_f32 v80, v80, v248
    v_mul_f32 v81, v81, v249
    v_cvt_pk_bf16_f32 v28, v80, v81
    v_mul_f32 v82, v82, v250
    v_mul_f32 v83, v83, v251
    v_cvt_pk_bf16_f32 v29, v82, v83
    v_mul_f32 v84, v84, v252
    v_mul_f32 v85, v85, v253
    v_cvt_pk_bf16_f32 v30, v84, v85
    v_mul_f32 v86, v86, v254
    v_mul_f32 v87, v87, v255
    v_cvt_pk_bf16_f32 v31, v86, v87
    buffer_store_dwordx4 v[28:31], v6, s[56:59], s73 offen sc1
    v_fma_f32 v96, -v40, v48, v96
    v_fma_f32 v104, -v40, v56, v104
    v_fma_f32 v97, -v40, v49, v97
    v_fma_f32 v105, -v40, v57, v105
    v_fma_f32 v98, -v40, v50, v98
    v_fma_f32 v106, -v40, v58, v106
    v_fma_f32 v99, -v40, v51, v99
    v_fma_f32 v107, -v40, v59, v107
    v_fma_f32 v100, -v40, v52, v100
    v_fma_f32 v108, -v40, v60, v108
    v_fma_f32 v101, -v40, v53, v101
    v_fma_f32 v109, -v40, v61, v109
    v_fma_f32 v102, -v40, v54, v102
    v_fma_f32 v110, -v40, v62, v110
    v_fma_f32 v103, -v40, v55, v103
    v_fma_f32 v111, -v40, v63, v111
    v_mul_f32 v240, v96, v42
    v_mul_f32 v96, v96, v104
    v_exp_f32 v240, v240
    v_mul_f32 v241, v97, v42
    v_mul_f32 v97, v97, v105
    v_exp_f32 v241, v241
    v_mul_f32 v242, v98, v42
    v_mul_f32 v98, v98, v106
    v_exp_f32 v242, v242
    v_mul_f32 v243, v99, v42
    v_mul_f32 v99, v99, v107
    v_exp_f32 v243, v243
    v_mul_f32 v244, v100, v42
    v_mul_f32 v100, v100, v108
    v_exp_f32 v244, v244
    v_mul_f32 v245, v101, v42
    v_mul_f32 v101, v101, v109
    v_exp_f32 v245, v245
    v_mul_f32 v246, v102, v42
    v_mul_f32 v102, v102, v110
    v_exp_f32 v246, v246
    v_mul_f32 v247, v103, v42
    v_mul_f32 v103, v103, v111
    v_exp_f32 v247, v247
    v_mul_f32 v96, v96, v43
    v_add_f32 v240, 1.0, v240
    v_rcp_f32 v240, v240
    v_mul_f32 v97, v97, v43
    v_add_f32 v241, 1.0, v241
    v_rcp_f32 v241, v241
    v_mul_f32 v98, v98, v43
    v_add_f32 v242, 1.0, v242
    v_rcp_f32 v242, v242
    v_mul_f32 v99, v99, v43
    v_add_f32 v243, 1.0, v243
    v_rcp_f32 v243, v243
    v_mul_f32 v100, v100, v43
    v_add_f32 v244, 1.0, v244
    v_rcp_f32 v244, v244
    v_mul_f32 v101, v101, v43
    v_add_f32 v245, 1.0, v245
    v_rcp_f32 v245, v245
    v_mul_f32 v102, v102, v43
    v_add_f32 v246, 1.0, v246
    v_rcp_f32 v246, v246
    v_mul_f32 v103, v103, v43
    v_add_f32 v247, 1.0, v247
    v_rcp_f32 v247, v247
    v_mul_f32 v96, v96, v240
    v_mul_f32 v97, v97, v241
    v_cvt_pk_bf16_f32 v24, v96, v97
    v_mul_f32 v98, v98, v242
    v_mul_f32 v99, v99, v243
    v_cvt_pk_bf16_f32 v25, v98, v99
    v_mul_f32 v100, v100, v244
    v_mul_f32 v101, v101, v245
    v_cvt_pk_bf16_f32 v26, v100, v101
    v_mul_f32 v102, v102, v246
    v_mul_f32 v103, v103, v247
    v_cvt_pk_bf16_f32 v27, v102, v103
    buffer_store_dwordx4 v[24:27], v6, s[56:59], s74 offen sc1
    v_fma_f32 v112, -v44, v48, v112
    v_fma_f32 v120, -v44, v56, v120
    v_fma_f32 v113, -v44, v49, v113
    v_fma_f32 v121, -v44, v57, v121
    v_fma_f32 v114, -v44, v50, v114
    v_fma_f32 v122, -v44, v58, v122
    v_fma_f32 v115, -v44, v51, v115
    v_fma_f32 v123, -v44, v59, v123
    v_fma_f32 v116, -v44, v52, v116
    v_fma_f32 v124, -v44, v60, v124
    v_fma_f32 v117, -v44, v53, v117
    v_fma_f32 v125, -v44, v61, v125
    v_fma_f32 v118, -v44, v54, v118
    v_fma_f32 v126, -v44, v62, v126
    v_fma_f32 v119, -v44, v55, v119
    v_fma_f32 v127, -v44, v63, v127
    v_mul_f32 v248, v112, v46
    v_mul_f32 v112, v112, v120
    v_exp_f32 v248, v248
    v_mul_f32 v249, v113, v46
    v_mul_f32 v113, v113, v121
    v_exp_f32 v249, v249
    v_mul_f32 v250, v114, v46
    v_mul_f32 v114, v114, v122
    v_exp_f32 v250, v250
    v_mul_f32 v251, v115, v46
    v_mul_f32 v115, v115, v123
    v_exp_f32 v251, v251
    v_mul_f32 v252, v116, v46
    v_mul_f32 v116, v116, v124
    v_exp_f32 v252, v252
    v_mul_f32 v253, v117, v46
    v_mul_f32 v117, v117, v125
    v_exp_f32 v253, v253
    v_mul_f32 v254, v118, v46
    v_mul_f32 v118, v118, v126
    v_exp_f32 v254, v254
    v_mul_f32 v255, v119, v46
    v_mul_f32 v119, v119, v127
    v_exp_f32 v255, v255
    v_mul_f32 v112, v112, v47
    v_add_f32 v248, 1.0, v248
    v_rcp_f32 v248, v248
    v_mul_f32 v113, v113, v47
    v_add_f32 v249, 1.0, v249
    v_rcp_f32 v249, v249
    v_mul_f32 v114, v114, v47
    v_add_f32 v250, 1.0, v250
    v_rcp_f32 v250, v250
    v_mul_f32 v115, v115, v47
    v_add_f32 v251, 1.0, v251
    v_rcp_f32 v251, v251
    v_mul_f32 v116, v116, v47
    v_add_f32 v252, 1.0, v252
    v_rcp_f32 v252, v252
    v_mul_f32 v117, v117, v47
    v_add_f32 v253, 1.0, v253
    v_rcp_f32 v253, v253
    v_mul_f32 v118, v118, v47
    v_add_f32 v254, 1.0, v254
    v_rcp_f32 v254, v254
    v_mul_f32 v119, v119, v47
    v_add_f32 v255, 1.0, v255
    v_rcp_f32 v255, v255
    v_mul_f32 v112, v112, v248
    v_mul_f32 v113, v113, v249
    v_cvt_pk_bf16_f32 v28, v112, v113
    v_mul_f32 v114, v114, v250
    v_mul_f32 v115, v115, v251
    v_cvt_pk_bf16_f32 v29, v114, v115
    v_mul_f32 v116, v116, v252
    v_mul_f32 v117, v117, v253
    v_cvt_pk_bf16_f32 v30, v116, v117
    v_mul_f32 v118, v118, v254
    v_mul_f32 v119, v119, v255
    v_cvt_pk_bf16_f32 v31, v118, v119
    buffer_store_dwordx4 v[28:31], v6, s[56:59], s75 offen sc1
    s_setprio 0
    s_waitcnt vmcnt(8)
    s_barrier
    ds_read_b64_tr_b16 v[148:149], v14 offset:0
    ds_read_b64_tr_b16 v[150:151], v14 offset:512
    ds_read_b64_tr_b16 v[152:153], v14 offset:8192
    ds_read_b64_tr_b16 v[154:155], v14 offset:8704
    ds_read_b64_tr_b16 v[156:157], v14 offset:16384
    ds_read_b64_tr_b16 v[158:159], v14 offset:16896
    ds_read_b64_tr_b16 v[160:161], v14 offset:40960
    ds_read_b64_tr_b16 v[162:163], v14 offset:41472
    ds_read_b64_tr_b16 v[164:165], v14 offset:24576
    ds_read_b64_tr_b16 v[166:167], v14 offset:25088
    ds_read_b64_tr_b16 v[168:169], v14 offset:32768
    ds_read_b64_tr_b16 v[170:171], v14 offset:33280
    ds_read_b64_tr_b16 v[172:173], v14 offset:49152
    ds_read_b64_tr_b16 v[174:175], v14 offset:49664
    ds_read_b64_tr_b16 v[176:177], v14 offset:57344
    ds_read_b64_tr_b16 v[178:179], v14 offset:57856
    ds_read_b64_tr_b16 v[180:181], v15 offset:0
    ds_read_b64_tr_b16 v[182:183], v15 offset:512
    ds_read_b64_tr_b16 v[184:185], v15 offset:49152
    ds_read_b64_tr_b16 v[186:187], v15 offset:49664
    ds_read_b64_tr_b16 v[188:189], v15 offset:57344
    ds_read_b64_tr_b16 v[190:191], v15 offset:57856
    ds_read_b64_tr_b16 v[192:193], v18 offset:0
    ds_read_b64_tr_b16 v[194:195], v18 offset:512
    ds_read_b64_tr_b16 v[196:197], v18 offset:8192
    ds_read_b64_tr_b16 v[198:199], v18 offset:8704
    ds_read_b64_tr_b16 v[200:201], v18 offset:16384
    ds_read_b64_tr_b16 v[202:203], v18 offset:16896
    ds_read_b64_tr_b16 v[204:205], v18 offset:24576
    ds_read_b64_tr_b16 v[206:207], v18 offset:25088
    s_add_u32 m0, s49, 73728
    s_mov_b32 s67, 286720
    buffer_load_dwordx4 v20, s[44:47], s67 offen lds
    s_add_u32 m0, s49, 81920
    s_mov_b32 s67, 301056
    buffer_load_dwordx4 v20, s[44:47], s67 offen lds
    s_add_u32 m0, s49, 90112
    s_mov_b32 s67, 315392
    buffer_load_dwordx4 v20, s[44:47], s67 offen lds
    s_add_u32 m0, s49, 98304
    s_mov_b32 s67, 329728
    buffer_load_dwordx4 v20, s[44:47], s67 offen lds
    s_waitcnt vmcnt(4)
    s_waitcnt lgkmcnt(0)
    s_barrier
    s_mul_i32 s64, s41, 14
    s_add_u32 s64, s64, s40
    s_lshl_b32 s64, s64, 6
    s_add_u32 s64, s64, 81920
    s_cmp_eq_u32 s32, 0
    s_cbranch_scc0 L_pub_3320
    v_mov_b32 v2, s33
    v_mov_b32 v3, s64
    s_mov_b64 exec, 1
    buffer_store_dword v2, v3, s[56:59], 0 offen sc1
    s_mov_b64 exec, -1
L_pub_3320:
    s_add_u32 m0, s49, 0
    s_mov_b32 s67, 344064
    buffer_load_dwordx4 v20, s[44:47], s67 offen lds
    s_add_u32 m0, s49, 8192
    s_mov_b32 s67, 358400
    buffer_load_dwordx4 v20, s[44:47], s67 offen lds
    s_add_u32 m0, s49, 16384
    s_mov_b32 s67, 372736
    buffer_load_dwordx4 v20, s[44:47], s67 offen lds
    s_add_u32 m0, s49, 24576
    s_mov_b32 s67, 387072
    buffer_load_dwordx4 v20, s[44:47], s67 offen lds
    s_mov_b32 s52, s26
    s_mov_b32 s53, s27
    s_mov_b32 s54, 1835008
    s_mov_b32 s55, 0x20000
    s_mul_i32 s40, s76, 28672
    s_lshl_b32 s64, s77, 10
    s_add_u32 s41, s40, s64
    v_and_b32 v23, 31, v1
    v_lshrrev_b32 v24, 5, v1
    s_lshl_b32 s64, s78, 6
    s_lshl_b32 s65, s77, 5
    s_add_u32 s64, s64, s65
    s_lshl_b32 s65, s50, 4
    s_add_u32 s34, s64, s65
    s_lshl_b32 s64, s79, 6
    s_and_b32 s65, s76, 1
    s_lshl_b32 s65, s65, 5
    s_add_u32 s35, s64, s65
    v_lshlrev_b32 v25, 3, v24
    v_add_u32 v25, s34, v25
    v_add_u32 v26, s35, v23
    v_mul_u32_u24 v27, 4352, v25
    v_lshl_add_u32 v27, v26, 1, v27
    v_add_u32 v27, 131072, v27
    s_mov_b32 s67, 0
    buffer_load_ushort v240, v27, s[56:59], s67 offen
    s_mov_b32 s67, 4352
    buffer_load_ushort v241, v27, s[56:59], s67 offen
    s_mov_b32 s67, 8704
    buffer_load_ushort v242, v27, s[56:59], s67 offen
    s_mov_b32 s67, 13056
    buffer_load_ushort v243, v27, s[56:59], s67 offen
    s_mov_b32 s67, 17408
    buffer_load_ushort v244, v27, s[56:59], s67 offen
    s_mov_b32 s67, 21760
    buffer_load_ushort v245, v27, s[56:59], s67 offen
    s_mov_b32 s67, 26112
    buffer_load_ushort v246, v27, s[56:59], s67 offen
    s_mov_b32 s67, 30464
    buffer_load_ushort v247, v27, s[56:59], s67 offen
    s_movk_i32 s64, 896
    v_mul_lo_u32 v28, v26, s64
    v_lshl_add_u32 v28, v25, 1, v28
    v_lshlrev_b32 v5, 4, v1
    s_lshl_b32 s64, s79, 1
    s_add_u32 s64, s64, s77
    s_mul_i32 s64, s64, 112
    s_mul_i32 s65, s76, 28
    s_add_u32 s64, s64, s65
    s_lshl_b32 s64, s64, 10
    s_add_u32 s64, s64, 4194304
    v_add_u32 v252, s64, v5
    v_add_u32 v6, s40, v5
    s_and_b32 s64, s76, 1
    s_lshl_b32 s64, s64, 10
    v_add_u32 v16, s64, v6
    s_xor_b32 s64, s64, 1024
    v_add_u32 v17, s64, v6
    v_mov_b32 v64, 0
    v_mov_b32 v65, 0
    v_mov_b32 v66, 0
    v_mov_b32 v67, 0
    v_mov_b32 v68, 0
    v_mov_b32 v69, 0
    v_mov_b32 v70, 0
    v_mov_b32 v71, 0
    v_mov_b32 v72, 0
    v_mov_b32 v73, 0
    v_mov_b32 v74, 0
    v_mov_b32 v75, 0
    v_mov_b32 v76, 0
    v_mov_b32 v77, 0
    v_mov_b32 v78, 0
    v_mov_b32 v79, 0
    v_mov_b32 v80, 0
    v_mov_b32 v81, 0
    v_mov_b32 v82, 0
    v_mov_b32 v83, 0
    v_mov_b32 v84, 0
    v_mov_b32 v85, 0
    v_mov_b32 v86, 0
    v_mov_b32 v87, 0
    v_mov_b32 v88, 0
    v_mov_b32 v89, 0
    v_mov_b32 v90, 0
    v_mov_b32 v91, 0
    v_mov_b32 v92, 0
    v_mov_b32 v93, 0
    v_mov_b32 v94, 0
    v_mov_b32 v95, 0
    s_lshr_b32 s64, s79, 1
    s_mul_i32 s64, s64, 896
    s_add_u32 s64, s64, 81920
    s_waitcnt vmcnt(0)
    s_barrier
    s_cmp_eq_u32 s32, 0
    s_cbranch_scc0 L_pi_s4
    v_lshlrev_b32 v32, 6, v1
    v_add_u32 v32, s64, v32
    v_min_u32 v33, 13, v1
    v_lshlrev_b32 v32, 6, v33
    v_add_u32 v32, s64, v32
    buffer_load_dword v33, v32, s[56:59], 0 offen sc1
L_pi_s4:
    ds_read_b64_tr_b16 v[208:209], v15 offset:8192
    ds_read_b64_tr_b16 v[210:211], v15 offset:8704
    ds_read_b64_tr_b16 v[212:213], v15 offset:16384
    ds_read_b64_tr_b16 v[214:215], v15 offset:16896
    ds_read_b64_tr_b16 v[216:217], v15 offset:24576
    ds_read_b64_tr_b16 v[218:219], v15 offset:25088
    ds_read_b64_tr_b16 v[220:221], v15 offset:32768
    ds_read_b64_tr_b16 v[222:223], v15 offset:33280
    ds_read_b64_tr_b16 v[224:225], v14 offset:0
    ds_read_b64_tr_b16 v[226:227], v14 offset:512
    ds_read_b64_tr_b16 v[228:229], v14 offset:8192
    ds_read_b64_tr_b16 v[230:231], v14 offset:8704
    ds_read_b64_tr_b16 v[232:233], v14 offset:16384
    ds_read_b64_tr_b16 v[234:235], v14 offset:16896
    ds_read_b64_tr_b16 v[236:237], v14 offset:24576
    ds_read_b64_tr_b16 v[238:239], v14 offset:25088
    s_waitcnt lgkmcnt(0)
    s_waitcnt vmcnt(0)
    s_cmp_eq_u32 s32, 0
    s_cbranch_scc0 L_pc_s4_bar
    s_mov_b32 s66, 0
L_pc_s4:
    v_xor_b32 v33, s33, v33
    v_cmp_ne_u32 vcc, 0, v33
    s_cbranch_vccz L_pc_s4_bar
    s_add_u32 s66, s66, 1
    s_cmp_gt_u32 s66, 30000
    s_cbranch_scc1 L_pc_s4_bar
    buffer_load_dword v33, v32, s[56:59], 0 offen sc1
    s_waitcnt vmcnt(0)
    s_branch L_pc_s4
L_pc_s4_bar:
    s_barrier
    s_add_u32 m0, s41, 0
    s_mov_b32 s67, 0
    buffer_load_dwordx4 v252, s[56:59], s67 offen lds
    s_add_u32 m0, s41, 2048
    s_mov_b32 s67, 1024
    buffer_load_dwordx4 v252, s[56:59], s67 offen lds
    s_add_u32 m0, s41, 4096
    s_mov_b32 s67, 2048
    buffer_load_dwordx4 v252, s[56:59], s67 offen lds
    s_add_u32 m0, s41, 6144
    s_mov_b32 s67, 3072
    buffer_load_dwordx4 v252, s[56:59], s67 offen lds
    s_add_u32 m0, s41, 8192
    s_mov_b32 s67, 4096
    buffer_load_dwordx4 v252, s[56:59], s67 offen lds
    s_add_u32 m0, s41, 10240
    s_mov_b32 s67, 5120
    buffer_load_dwordx4 v252, s[56:59], s67 offen lds
    s_add_u32 m0, s41, 12288
    s_mov_b32 s67, 6144
    buffer_load_dwordx4 v252, s[56:59], s67 offen lds
    s_add_u32 m0, s41, 14336
    s_mov_b32 s67, 7168
    buffer_load_dwordx4 v252, s[56:59], s67 offen lds
    s_waitcnt vmcnt(4)
    s_barrier
    ds_read_b128 v[32:35], v16 offset:0
    ds_read_b128 v[36:39], v17 offset:0
    ds_read_b128 v[40:43], v16 offset:2048
    ds_read_b128 v[44:47], v17 offset:2048
    ds_read_b128 v[48:51], v16 offset:4096
    ds_read_b128 v[52:55], v17 offset:4096
    s_waitcnt lgkmcnt(4)
    v_mfma_f32_32x32x16_bf16 v[64:79], v[128:131], v[32:35], v[64:79]
    ds_read_b128 v[56:59], v16 offset:6144
    v_mfma_f32_32x32x16_bf16 v[80:95], v[128:131], v[36:39], v[80:95]
    ds_read_b128 v[60:63], v17 offset:6144
    s_add_u32 m0, s41, 16384
    s_mov_b32 s67, 8192
    buffer_load_dwordx4 v252, s[56:59], s67 offen lds
    s_add_u32 m0, s41, 18432
    s_mov_b32 s67, 9216
    buffer_load_dwordx4 v252, s[56:59], s67 offen lds
    s_add_u32 m0, s41, 20480
    s_mov_b32 s67, 10240
    buffer_load_dwordx4 v252, s[56:59], s67 offen lds
    s_add_u32 m0, s41, 22528
    s_mov_b32 s67, 11264
    buffer_load_dwordx4 v252, s[56:59], s67 offen lds
    s_waitcnt lgkmcnt(4)
    s_waitcnt vmcnt(4)
    s_barrier
    v_mfma_f32_32x32x16_bf16 v[64:79], v[132:135], v[40:43], v[64:79]
    ds_read_b128 v[32:35], v16 offset:8192
    v_mfma_f32_32x32x16_bf16 v[80:95], v[132:135], v[44:47], v[80:95]
    ds_read_b128 v[36:39], v17 offset:8192
    s_add_u32 m0, s41, 24576
    s_mov_b32 s67, 12288
    buffer_load_dwordx4 v252, s[56:59], s67 offen lds
    s_add_u32 m0, s41, 26624
    s_mov_b32 s67, 13312
    buffer_load_dwordx4 v252, s[56:59], s67 offen lds
    s_add_u32 m0, s41, 0
    s_mov_b32 s67, 14336
    buffer_load_dwordx4 v252, s[56:59], s67 offen lds
    s_waitcnt lgkmcnt(4)
    v_mfma_f32_32x32x16_bf16 v[64:79], v[136:139], v[48:51], v[64:79]
    ds_read_b128 v[40:43], v16 offset:10240
    v_mfma_f32_32x32x16_bf16 v[80:95], v[136:139], v[52:55], v[80:95]
    ds_read_b128 v[44:47], v17 offset:10240
    s_add_u32 m0, s41, 2048
    s_mov_b32 s67, 15360
    buffer_load_dwordx4 v252, s[56:59], s67 offen lds
    s_waitcnt lgkmcnt(4)
    v_mfma_f32_32x32x16_bf16 v[64:79], v[140:143], v[56:59], v[64:79]
    ds_read_b128 v[48:51], v16 offset:12288
    v_mfma_f32_32x32x16_bf16 v[80:95], v[140:143], v[60:63], v[80:95]
    ds_read_b128 v[52:55], v17 offset:12288
    s_waitcnt lgkmcnt(4)
    v_mfma_f32_32x32x16_bf16 v[64:79], v[144:147], v[32:35], v[64:79]
    ds_read_b128 v[56:59], v16 offset:14336
    v_mfma_f32_32x32x16_bf16 v[80:95], v[144:147], v[36:39], v[80:95]
    ds_read_b128 v[60:63], v17 offset:14336
    s_waitcnt lgkmcnt(4)
    s_waitcnt vmcnt(4)
    s_barrier
    v_mfma_f32_32x32x16_bf16 v[64:79], v[148:151], v[40:43], v[64:79]
    ds_read_b128 v[32:35], v16 offset:16384
    v_mfma_f32_32x32x16_bf16 v[80:95], v[148:151], v[44:47], v[80:95]
    ds_read_b128 v[36:39], v17 offset:16384
    s_add_u32 m0, s41, 4096
    s_mov_b32 s67, 16384
    buffer_load_dwordx4 v252, s[56:59], s67 offen lds
    s_add_u32 m0, s41, 6144
    s_mov_b32 s67, 17408
    buffer_load_dwordx4 v252, s[56:59], s67 offen lds
    s_waitcnt lgkmcnt(4)
    v_mfma_f32_32x32x16_bf16 v[64:79], v[152:155], v[48:51], v[64:79]
    ds_read_b128 v[40:43], v16 offset:18432
    v_mfma_f32_32x32x16_bf16 v[80:95], v[152:155], v[52:55], v[80:95]
    ds_read_b128 v[44:47], v17 offset:18432
    s_add_u32 m0, s41, 8192
    s_mov_b32 s67, 18432
    buffer_load_dwordx4 v252, s[56:59], s67 offen lds
    s_add_u32 m0, s41, 10240
    s_mov_b32 s67, 19456
    buffer_load_dwordx4 v252, s[56:59], s67 offen lds
    s_waitcnt lgkmcnt(4)
    v_mfma_f32_32x32x16_bf16 v[64:79], v[156:159], v[56:59], v[64:79]
    ds_read_b128 v[48:51], v16 offset:20480
    v_mfma_f32_32x32x16_bf16 v[80:95], v[156:159], v[60:63], v[80:95]
    ds_read_b128 v[52:55], v17 offset:20480
    s_waitcnt lgkmcnt(4)
    v_mfma_f32_32x32x16_bf16 v[64:79], v[160:163], v[32:35], v[64:79]
    ds_read_b128 v[56:59], v16 offset:22528
    v_mfma_f32_32x32x16_bf16 v[80:95], v[160:163], v[36:39], v[80:95]
    ds_read_b128 v[60:63], v17 offset:22528
    s_waitcnt lgkmcnt(4)
    s_waitcnt vmcnt(4)
    s_barrier
    v_mfma_f32_32x32x16_bf16 v[64:79], v[164:167], v[40:43], v[64:79]
    ds_read_b128 v[32:35], v16 offset:24576
    v_mfma_f32_32x32x16_bf16 v[80:95], v[164:167], v[44:47], v[80:95]
    ds_read_b128 v[36:39], v17 offset:24576
    s_add_u32 m0, s41, 12288
    s_mov_b32 s67, 20480
    buffer_load_dwordx4 v252, s[56:59], s67 offen lds
    s_add_u32 m0, s41, 14336
    s_mov_b32 s67, 21504
    buffer_load_dwordx4 v252, s[56:59], s67 offen lds
    s_waitcnt lgkmcnt(4)
    v_mfma_f32_32x32x16_bf16 v[64:79], v[168:171], v[48:51], v[64:79]
    ds_read_b128 v[40:43], v16 offset:26624
    v_mfma_f32_32x32x16_bf16 v[80:95], v[168:171], v[52:55], v[80:95]
    ds_read_b128 v[44:47], v17 offset:26624
    s_add_u32 m0, s41, 16384
    s_mov_b32 s67, 22528
    buffer_load_dwordx4 v252, s[56:59], s67 offen lds
    s_add_u32 m0, s41, 18432
    s_mov_b32 s67, 23552
    buffer_load_dwordx4 v252, s[56:59], s67 offen lds
    s_waitcnt lgkmcnt(4)
    v_mfma_f32_32x32x16_bf16 v[64:79], v[172:175], v[56:59], v[64:79]
    ds_read_b128 v[48:51], v16 offset:0
    v_mfma_f32_32x32x16_bf16 v[80:95], v[172:175], v[60:63], v[80:95]
    ds_read_b128 v[52:55], v17 offset:0
    s_waitcnt lgkmcnt(4)
    v_mfma_f32_32x32x16_bf16 v[64:79], v[176:179], v[32:35], v[64:79]
    ds_read_b128 v[56:59], v16 offset:2048
    v_mfma_f32_32x32x16_bf16 v[80:95], v[176:179], v[36:39], v[80:95]
    ds_read_b128 v[60:63], v17 offset:2048
    s_waitcnt lgkmcnt(4)
    s_waitcnt vmcnt(4)
    s_barrier
    v_mfma_f32_32x32x16_bf16 v[64:79], v[180:183], v[40:43], v[64:79]
    ds_read_b128 v[32:35], v16 offset:4096
    v_mfma_f32_32x32x16_bf16 v[80:95], v[180:183], v[44:47], v[80:95]
    ds_read_b128 v[36:39], v17 offset:4096
    s_add_u32 m0, s41, 20480
    s_mov_b32 s67, 24576
    buffer_load_dwordx4 v252, s[56:59], s67 offen lds
    s_add_u32 m0, s41, 22528
    s_mov_b32 s67, 25600
    buffer_load_dwordx4 v252, s[56:59], s67 offen lds
    s_waitcnt lgkmcnt(4)
    v_mfma_f32_32x32x16_bf16 v[64:79], v[184:187], v[48:51], v[64:79]
    ds_read_b128 v[40:43], v16 offset:6144
    v_mfma_f32_32x32x16_bf16 v[80:95], v[184:187], v[52:55], v[80:95]
    ds_read_b128 v[44:47], v17 offset:6144
    s_add_u32 m0, s41, 24576
    s_mov_b32 s67, 26624
    buffer_load_dwordx4 v252, s[56:59], s67 offen lds
    s_add_u32 m0, s41, 26624
    s_mov_b32 s67, 27648
    buffer_load_dwordx4 v252, s[56:59], s67 offen lds
    s_waitcnt lgkmcnt(4)
    v_mfma_f32_32x32x16_bf16 v[64:79], v[188:191], v[56:59], v[64:79]
    ds_read_b128 v[48:51], v16 offset:8192
    v_mfma_f32_32x32x16_bf16 v[80:95], v[188:191], v[60:63], v[80:95]
    ds_read_b128 v[52:55], v17 offset:8192
    s_waitcnt lgkmcnt(4)
    v_mfma_f32_32x32x16_bf16 v[64:79], v[192:195], v[32:35], v[64:79]
    ds_read_b128 v[56:59], v16 offset:10240
    v_mfma_f32_32x32x16_bf16 v[80:95], v[192:195], v[36:39], v[80:95]
    ds_read_b128 v[60:63], v17 offset:10240
    s_waitcnt lgkmcnt(4)
    s_waitcnt vmcnt(4)
    s_barrier
    v_mfma_f32_32x32x16_bf16 v[64:79], v[196:199], v[40:43], v[64:79]
    ds_read_b128 v[32:35], v16 offset:12288
    v_mfma_f32_32x32x16_bf16 v[80:95], v[196:199], v[44:47], v[80:95]
    ds_read_b128 v[36:39], v17 offset:12288
    s_waitcnt lgkmcnt(4)
    v_mfma_f32_32x32x16_bf16 v[64:79], v[200:203], v[48:51], v[64:79]
    ds_read_b128 v[40:43], v16 offset:14336
    v_mfma_f32_32x32x16_bf16 v[80:95], v[200:203], v[52:55], v[80:95]
    ds_read_b128 v[44:47], v17 offset:14336
    s_waitcnt lgkmcnt(4)
    v_mfma_f32_32x32x16_bf16 v[64:79], v[204:207], v[56:59], v[64:79]
    ds_read_b128 v[48:51], v16 offset:16384
    v_mfma_f32_32x32x16_bf16 v[80:95], v[204:207], v[60:63], v[80:95]
    ds_read_b128 v[52:55], v17 offset:16384
    s_waitcnt lgkmcnt(4)
    v_mfma_f32_32x32x16_bf16 v[64:79], v[208:211], v[32:35], v[64:79]
    ds_read_b128 v[56:59], v16 offset:18432
    v_mfma_f32_32x32x16_bf16 v[80:95], v[208:211], v[36:39], v[80:95]
    ds_read_b128 v[60:63], v17 offset:18432
    s_waitcnt lgkmcnt(4)
    s_waitcnt vmcnt(0)
    s_barrier
    v_mfma_f32_32x32x16_bf16 v[64:79], v[212:215], v[40:43], v[64:79]
    ds_read_b128 v[32:35], v16 offset:20480
    v_mfma_f32_32x32x16_bf16 v[80:95], v[212:215], v[44:47], v[80:95]
    ds_read_b128 v[36:39], v17 offset:20480
    s_waitcnt lgkmcnt(4)
    v_mfma_f32_32x32x16_bf16 v[64:79], v[216:219], v[48:51], v[64:79]
    ds_read_b128 v[40:43], v16 offset:22528
    v_mfma_f32_32x32x16_bf16 v[80:95], v[216:219], v[52:55], v[80:95]
    ds_read_b128 v[44:47], v17 offset:22528
    s_waitcnt lgkmcnt(4)
    v_mfma_f32_32x32x16_bf16 v[64:79], v[220:223], v[56:59], v[64:79]
    ds_read_b128 v[48:51], v16 offset:24576
    v_mfma_f32_32x32x16_bf16 v[80:95], v[220:223], v[60:63], v[80:95]
    ds_read_b128 v[52:55], v17 offset:24576
    s_waitcnt lgkmcnt(4)
    v_mfma_f32_32x32x16_bf16 v[64:79], v[224:227], v[32:35], v[64:79]
    ds_read_b128 v[56:59], v16 offset:26624
    v_mfma_f32_32x32x16_bf16 v[80:95], v[224:227], v[36:39], v[80:95]
    ds_read_b128 v[60:63], v17 offset:26624
    s_waitcnt lgkmcnt(4)
    v_mfma_f32_32x32x16_bf16 v[64:79], v[228:231], v[40:43], v[64:79]
    v_mfma_f32_32x32x16_bf16 v[80:95], v[228:231], v[44:47], v[80:95]
    s_waitcnt lgkmcnt(2)
    v_mfma_f32_32x32x16_bf16 v[64:79], v[232:235], v[48:51], v[64:79]
    v_mfma_f32_32x32x16_bf16 v[80:95], v[232:235], v[52:55], v[80:95]
    s_waitcnt lgkmcnt(0)
    v_mfma_f32_32x32x16_bf16 v[64:79], v[236:239], v[56:59], v[64:79]
    v_mfma_f32_32x32x16_bf16 v[80:95], v[236:239], v[60:63], v[80:95]
    v_lshlrev_b32 v8, 4, v1
    s_xor_b32 s64, s32, 1
    s_mul_i32 s64, s64, 6144
    s_add_u32 s64, s64, 114688
    v_add_u32 v22, s64, v8
    s_nop 6
    ds_write_b128 v22, v[80:83]
    ds_write_b128 v22, v[84:87] offset:1024
    s_xor_b32 s64, s32, 2
    s_mul_i32 s64, s64, 6144
    s_add_u32 s64, s64, 116736
    v_add_u32 v22, s64, v8
    ds_write_b128 v22, v[72:75]
    ds_write_b128 v22, v[76:79] offset:1024
    s_xor_b32 s64, s32, 3
    s_mul_i32 s64, s64, 6144
    s_add_u32 s64, s64, 118784
    v_add_u32 v22, s64, v8
    ds_write_b128 v22, v[88:91]
    ds_write_b128 v22, v[92:95] offset:1024
    s_mul_i32 s64, s32, 6144
    s_add_u32 s64, s64, 114688
    v_add_u32 v22, s64, v8
    s_waitcnt lgkmcnt(0)
    s_barrier
    ds_read_b128 v[96:99], v22 offset:0
    ds_read_b128 v[100:103], v22 offset:1024
    ds_read_b128 v[104:107], v22 offset:2048
    ds_read_b128 v[108:111], v22 offset:3072
    ds_read_b128 v[112:115], v22 offset:4096
    ds_read_b128 v[116:119], v22 offset:5120
    s_waitcnt lgkmcnt(0)
    v_add_f32 v64, v64, v96
    v_add_f32 v65, v65, v97
    v_add_f32 v66, v66, v98
    v_add_f32 v67, v67, v99
    v_add_f32 v68, v68, v100
    v_add_f32 v69, v69, v101
    v_add_f32 v70, v70, v102
    v_add_f32 v71, v71, v103
    v_add_f32 v64, v64, v104
    v_add_f32 v65, v65, v105
    v_add_f32 v66, v66, v106
    v_add_f32 v67, v67, v107
    v_add_f32 v68, v68, v108
    v_add_f32 v69, v69, v109
    v_add_f32 v70, v70, v110
    v_add_f32 v71, v71, v111
    v_add_f32 v64, v64, v112
    v_add_f32 v65, v65, v113
    v_add_f32 v66, v66, v114
    v_add_f32 v67, v67, v115
    v_add_f32 v68, v68, v116
    v_add_f32 v69, v69, v117
    v_add_f32 v70, v70, v118
    v_add_f32 v71, v71, v119
    v_cvt_pk_bf16_f32 v30, v64, v65
    v_lshlrev_b32 v31, 16, v30
    v_and_b32 v30, 0xffff0000, v30
    v_lshlrev_b32 v32, 16, v240
    v_lshlrev_b32 v33, 16, v241
    v_add_f32 v31, v31, v32
    v_add_f32 v30, v30, v33
    v_cvt_pk_bf16_f32 v120, v31, v30
    v_cvt_pk_bf16_f32 v30, v66, v67
    v_lshlrev_b32 v31, 16, v30
    v_and_b32 v30, 0xffff0000, v30
    v_lshlrev_b32 v32, 16, v242
    v_lshlrev_b32 v33, 16, v243
    v_add_f32 v31, v31, v32
    v_add_f32 v30, v30, v33
    v_cvt_pk_bf16_f32 v121, v31, v30
    v_cvt_pk_bf16_f32 v30, v68, v69
    v_lshlrev_b32 v31, 16, v30
    v_and_b32 v30, 0xffff0000, v30
    v_lshlrev_b32 v32, 16, v244
    v_lshlrev_b32 v33, 16, v245
    v_add_f32 v31, v31, v32
    v_add_f32 v30, v30, v33
    v_cvt_pk_bf16_f32 v122, v31, v30
    v_cvt_pk_bf16_f32 v30, v70, v71
    v_lshlrev_b32 v31, 16, v30
    v_and_b32 v30, 0xffff0000, v30
    v_lshlrev_b32 v32, 16, v246
    v_lshlrev_b32 v33, 16, v247
    v_add_f32 v31, v31, v32
    v_add_f32 v30, v30, v33
    v_cvt_pk_bf16_f32 v123, v31, v30
    buffer_store_dwordx4 v[120:123], v28, s[52:55], 0 offen
    s_waitcnt vmcnt(0)
    s_waitcnt vmcnt(0)
    s_endpgm
L_helper:
    s_sub_u32 s70, s2, 224
    s_mov_b32 s36, s4
    s_mov_b32 s37, s5
    s_mov_b32 s38, 1835008
    s_mov_b32 s39, 0x20000
    s_lshl_b32 s64, s2, 3
    s_add_u32 s64, s64, s32
    s_mul_i32 s64, s64, 896
    v_lshl_add_u32 v194, v1, 4, s64
    v_mov_b32 v196, 0
    v_mov_b32 v197, 0
    v_mov_b32 v198, 0
    v_mov_b32 v199, 0
    v_cmp_gt_u32 vcc, 56, v1
    s_nop 3
    s_and_saveexec_b64 s[66:67], vcc
    buffer_load_dwordx4 v[196:199], v194, s[36:39], 0 offen
    s_mov_b64 exec, s[66:67]
    v_mov_b32 v193, 0
    buffer_load_dword v195, v193, s[60:63], 0 offen sc1
    s_waitcnt vmcnt(1)
    s_mul_i32 s64, s32, 912
    s_add_u32 s64, s64, 142848
    v_lshl_add_u32 v194, v1, 4, s64
    v_cmp_gt_u32 vcc, 56, v1
    s_nop 3
    s_and_saveexec_b64 s[66:67], vcc
    ds_write_b128 v194, v[196:199]
    s_mov_b64 exec, s[66:67]
    v_bfe_u32 v184, v1, 2, 2
    v_mul_u32_u24 v184, 912, v184
    v_lshrrev_b32 v185, 4, v1
    v_lshl_add_u32 v184, v185, 5, v184
    v_and_b32 v185, 3, v1
    v_lshl_add_u32 v184, v185, 3, v184
    s_lshl_b32 s64, s32, 7
    s_add_u32 s64, s64, 142848
    v_add_u32 v184, s64, v184
    s_mul_i32 s64, s2, 7168
    s_lshl_b32 s65, s32, 10
    s_add_u32 s64, s64, s65
    s_add_u32 s64, s64, 2097152
    v_lshl_add_u32 v185, v1, 4, s64
    s_waitcnt lgkmcnt(0)
    s_barrier
    s_cmp_ge_u32 s32, 7
    s_cbranch_scc1 L_xp_notr_h
    ds_read_b64_tr_b16 v[180:181], v184
    ds_read_b64_tr_b16 v[182:183], v184 offset:3648
    s_waitcnt lgkmcnt(0)
    buffer_store_dwordx4 v[180:183], v185, s[56:59], 0 offen sc1
L_xp_notr_h:
    v_mov_b32 v190, 0x3f803f80
    v_mov_b32 v188, 0
    v_mov_b32 v189, 0
    v_dot2_f32_bf16 v188, v196, v190, v188
    v_dot2_f32_bf16 v189, v196, v196, v189
    v_dot2_f32_bf16 v188, v197, v190, v188
    v_dot2_f32_bf16 v189, v197, v197, v189
    v_dot2_f32_bf16 v188, v198, v190, v188
    v_dot2_f32_bf16 v189, v198, v198, v189
    v_dot2_f32_bf16 v188, v199, v190, v188
    v_dot2_f32_bf16 v189, v199, v199, v189
    s_nop 1
    v_add_f32_dpp v188, v188, v188 quad_perm:[1,0,3,2] row_mask:0xf bank_mask:0xf
    v_add_f32_dpp v189, v189, v189 quad_perm:[1,0,3,2] row_mask:0xf bank_mask:0xf
    s_nop 0
    v_add_f32_dpp v188, v188, v188 quad_perm:[2,3,0,1] row_mask:0xf bank_mask:0xf
    v_add_f32_dpp v189, v189, v189 quad_perm:[2,3,0,1] row_mask:0xf bank_mask:0xf
    s_nop 0
    v_add_f32_dpp v188, v188, v188 row_half_mirror row_mask:0xf bank_mask:0xf
    v_add_f32_dpp v189, v189, v189 row_half_mirror row_mask:0xf bank_mask:0xf
    s_nop 0
    v_add_f32_dpp v188, v188, v188 row_mirror row_mask:0xf bank_mask:0xf
    v_add_f32_dpp v189, v189, v189 row_mirror row_mask:0xf bank_mask:0xf
    v_mov_b32 v186, v188
    v_mov_b32 v187, v189
    s_nop 0
    v_permlane16_swap_b32 v188, v186
    v_permlane16_swap_b32 v189, v187
    v_add_f32 v188, v188, v186
    v_add_f32 v189, v189, v187
    v_mov_b32 v186, v188
    v_mov_b32 v187, v189
    s_nop 0
    v_permlane32_swap_b32 v188, v186
    v_permlane32_swap_b32 v189, v187
    v_add_f32 v188, v188, v186
    v_add_f32 v189, v189, v187
    v_mul_f32 v188, 0x3b124925, v188
    v_mul_f32 v189, 0x3b124925, v189
    v_fma_f32 v189, -v188, v188, v189
    v_max_f32 v189, 0, v189
    v_cvt_pk_bf16_f32 v184, v189, v188
    v_lshlrev_b32 v185, 16, v184
    v_add_f32 v185, 0x3727c5ac, v185
    v_cvt_pk_bf16_f32 v185, v185, v185
    v_lshlrev_b32 v185, 16, v185
    v_sqrt_f32 v185, v185
    s_nop 0
    v_cvt_pk_bf16_f32 v185, v185, v185
    v_lshrrev_b32 v184, 16, v184
    v_and_b32 v185, 0xffff0000, v185
    v_or_b32 v186, v184, v185
    v_and_b32 v187, 0xffff0000, v186
    v_lshlrev_b32 v186, 16, v186
    v_rcp_f32 v188, v187
    s_nop 0
    v_mul_f32_e64 v189, -v186, v188
    s_lshl_b32 s64, s2, 6
    s_lshl_b32 s65, s32, 3
    s_add_u32 s64, s64, s65
    v_mov_b32 v187, s64
    s_mov_b64 exec, 1
    buffer_store_dwordx2 v[188:189], v187, s[56:59], 0 offen offset:0 sc1
    s_mov_b64 exec, -1
    s_waitcnt vmcnt(0)
    v_readfirstlane_b32 s33, v195
    s_nop 3
    s_cmp_eq_u32 s33, 0
    s_cbranch_scc0 L_xp_got_h
    v_mov_b32 v195, 0
    s_mov_b32 s66, 0
L_nonce_xph:
    buffer_load_dword v194, v195, s[60:63], 0 offen sc1
    s_waitcnt vmcnt(0)
    v_readfirstlane_b32 s33, v194
    s_add_u32 s66, s66, 1
    s_cmp_gt_u32 s66, 30000
    s_cbranch_scc1 L_nonce_xph_ok
    s_nop 0
    s_cmp_eq_u32 s33, 0
    s_cbranch_scc1 L_nonce_xph
L_nonce_xph_ok:
L_xp_got_h:
L_xp_have_h:
    s_barrier
    s_lshl_b32 s64, s2, 6
    s_add_u32 s64, s64, 98304
    s_cmp_eq_u32 s32, 0
    s_cbranch_scc0 L_pub_3934
    v_mov_b32 v194, s33
    v_mov_b32 v195, s64
    s_mov_b64 exec, 1
    buffer_store_dword v194, v195, s[56:59], 0 offen sc1
    s_mov_b64 exec, -1
L_pub_3934:
    s_mul_i32 s64, s70, 392
    v_min_u32 v170, 391, v0
    v_add_u32 v170, s64, v170
    v_lshlrev_b32 v170, 7, v170
    s_mov_b32 s76, s20
    s_mov_b32 s77, s21
    s_mov_b32 s78, 1605632
    s_mov_b32 s79, 0x20000
    buffer_load_dword v171, v170, s[76:79], 0 offen
    s_mov_b32 s76, s22
    s_mov_b32 s77, s23
    s_mov_b32 s78, 1605632
    s_mov_b32 s79, 0x20000
    buffer_load_dword v172, v170, s[76:79], 0 offen
    s_mov_b32 s76, s24
    s_mov_b32 s77, s25
    s_mov_b32 s78, 1605632
    s_mov_b32 s79, 0x20000
    buffer_load_dword v173, v170, s[76:79], 0 offen
    s_cmp_lt_u32 s70, 16
    s_cselect_b32 s36, s20, s22
    s_cselect_b32 s37, s21, s23
    s_mov_b32 s38, 1605632
    s_mov_b32 s39, 0x20000
    s_and_b32 s64, s70, 15
    s_mul_i32 s64, s64, 224
    v_lshrrev_b32 v2, 4, v1
    v_and_b32 v3, 15, v1
    s_mul_i32 s65, s32, 56
    v_add_u32 v4, s65, v2
    s_movk_i32 s65, 3584
    v_mul_lo_u32 v4, v4, s65
    v_lshl_add_u32 v4, v3, 4, v4
    v_add_u32 v4, s64, v4
    s_mov_b32 s67, 0
    buffer_load_dwordx4 v[8:11], v4, s[36:39], s67 offen
    s_mov_b32 s67, 14336
    buffer_load_dwordx4 v[12:15], v4, s[36:39], s67 offen
    s_mov_b32 s67, 28672
    buffer_load_dwordx4 v[16:19], v4, s[36:39], s67 offen
    s_mov_b32 s67, 43008
    buffer_load_dwordx4 v[20:23], v4, s[36:39], s67 offen
    s_mov_b32 s67, 57344
    buffer_load_dwordx4 v[24:27], v4, s[36:39], s67 offen
    s_mov_b32 s67, 71680
    buffer_load_dwordx4 v[28:31], v4, s[36:39], s67 offen
    s_mov_b32 s67, 86016
    buffer_load_dwordx4 v[32:35], v4, s[36:39], s67 offen
    s_mov_b32 s67, 100352
    buffer_load_dwordx4 v[36:39], v4, s[36:39], s67 offen
    s_mov_b32 s67, 114688
    buffer_load_dwordx4 v[40:43], v4, s[36:39], s67 offen
    s_mov_b32 s67, 129024
    buffer_load_dwordx4 v[44:47], v4, s[36:39], s67 offen
    s_mov_b32 s67, 143360
    buffer_load_dwordx4 v[48:51], v4, s[36:39], s67 offen
    s_mov_b32 s67, 157696
    buffer_load_dwordx4 v[52:55], v4, s[36:39], s67 offen
    s_mov_b32 s67, 172032
    buffer_load_dwordx4 v[56:59], v4, s[36:39], s67 offen
    s_mov_b32 s67, 186368
    buffer_load_dwordx4 v[60:63], v4, s[36:39], s67 offen
    v_mov_b32 v72, 0
    v_mov_b32 v73, 0
    v_mov_b32 v74, 0
    v_mov_b32 v75, 0
    v_mov_b32 v76, 0
    v_mov_b32 v77, 0
    v_mov_b32 v78, 0
    v_mov_b32 v79, 0
    s_waitcnt vmcnt(13)
    v_lshlrev_b32 v80, 16, v8
    v_and_b32 v81, 0xffff0000, v8
    v_add_f32 v72, v72, v80
    v_add_f32 v73, v73, v81
    v_lshlrev_b32 v80, 16, v9
    v_and_b32 v81, 0xffff0000, v9
    v_add_f32 v74, v74, v80
    v_add_f32 v75, v75, v81
    v_lshlrev_b32 v80, 16, v10
    v_and_b32 v81, 0xffff0000, v10
    v_add_f32 v76, v76, v80
    v_add_f32 v77, v77, v81
    v_lshlrev_b32 v80, 16, v11
    v_and_b32 v81, 0xffff0000, v11
    v_add_f32 v78, v78, v80
    v_add_f32 v79, v79, v81
    s_waitcnt vmcnt(12)
    v_lshlrev_b32 v80, 16, v12
    v_and_b32 v81, 0xffff0000, v12
    v_add_f32 v72, v72, v80
    v_add_f32 v73, v73, v81
    v_lshlrev_b32 v80, 16, v13
    v_and_b32 v81, 0xffff0000, v13
    v_add_f32 v74, v74, v80
    v_add_f32 v75, v75, v81
    v_lshlrev_b32 v80, 16, v14
    v_and_b32 v81, 0xffff0000, v14
    v_add_f32 v76, v76, v80
    v_add_f32 v77, v77, v81
    v_lshlrev_b32 v80, 16, v15
    v_and_b32 v81, 0xffff0000, v15
    v_add_f32 v78, v78, v80
    v_add_f32 v79, v79, v81
    s_waitcnt vmcnt(11)
    v_lshlrev_b32 v80, 16, v16
    v_and_b32 v81, 0xffff0000, v16
    v_add_f32 v72, v72, v80
    v_add_f32 v73, v73, v81
    v_lshlrev_b32 v80, 16, v17
    v_and_b32 v81, 0xffff0000, v17
    v_add_f32 v74, v74, v80
    v_add_f32 v75, v75, v81
    v_lshlrev_b32 v80, 16, v18
    v_and_b32 v81, 0xffff0000, v18
    v_add_f32 v76, v76, v80
    v_add_f32 v77, v77, v81
    v_lshlrev_b32 v80, 16, v19
    v_and_b32 v81, 0xffff0000, v19
    v_add_f32 v78, v78, v80
    v_add_f32 v79, v79, v81
    s_waitcnt vmcnt(10)
    v_lshlrev_b32 v80, 16, v20
    v_and_b32 v81, 0xffff0000, v20
    v_add_f32 v72, v72, v80
    v_add_f32 v73, v73, v81
    v_lshlrev_b32 v80, 16, v21
    v_and_b32 v81, 0xffff0000, v21
    v_add_f32 v74, v74, v80
    v_add_f32 v75, v75, v81
    v_lshlrev_b32 v80, 16, v22
    v_and_b32 v81, 0xffff0000, v22
    v_add_f32 v76, v76, v80
    v_add_f32 v77, v77, v81
    v_lshlrev_b32 v80, 16, v23
    v_and_b32 v81, 0xffff0000, v23
    v_add_f32 v78, v78, v80
    v_add_f32 v79, v79, v81
    s_waitcnt vmcnt(9)
    v_lshlrev_b32 v80, 16, v24
    v_and_b32 v81, 0xffff0000, v24
    v_add_f32 v72, v72, v80
    v_add_f32 v73, v73, v81
    v_lshlrev_b32 v80, 16, v25
    v_and_b32 v81, 0xffff0000, v25
    v_add_f32 v74, v74, v80
    v_add_f32 v75, v75, v81
    v_lshlrev_b32 v80, 16, v26
    v_and_b32 v81, 0xffff0000, v26
    v_add_f32 v76, v76, v80
    v_add_f32 v77, v77, v81
    v_lshlrev_b32 v80, 16, v27
    v_and_b32 v81, 0xffff0000, v27
    v_add_f32 v78, v78, v80
    v_add_f32 v79, v79, v81
    s_waitcnt vmcnt(8)
    v_lshlrev_b32 v80, 16, v28
    v_and_b32 v81, 0xffff0000, v28
    v_add_f32 v72, v72, v80
    v_add_f32 v73, v73, v81
    v_lshlrev_b32 v80, 16, v29
    v_and_b32 v81, 0xffff0000, v29
    v_add_f32 v74, v74, v80
    v_add_f32 v75, v75, v81
    v_lshlrev_b32 v80, 16, v30
    v_and_b32 v81, 0xffff0000, v30
    v_add_f32 v76, v76, v80
    v_add_f32 v77, v77, v81
    v_lshlrev_b32 v80, 16, v31
    v_and_b32 v81, 0xffff0000, v31
    v_add_f32 v78, v78, v80
    v_add_f32 v79, v79, v81
    s_waitcnt vmcnt(7)
    v_lshlrev_b32 v80, 16, v32
    v_and_b32 v81, 0xffff0000, v32
    v_add_f32 v72, v72, v80
    v_add_f32 v73, v73, v81
    v_lshlrev_b32 v80, 16, v33
    v_and_b32 v81, 0xffff0000, v33
    v_add_f32 v74, v74, v80
    v_add_f32 v75, v75, v81
    v_lshlrev_b32 v80, 16, v34
    v_and_b32 v81, 0xffff0000, v34
    v_add_f32 v76, v76, v80
    v_add_f32 v77, v77, v81
    v_lshlrev_b32 v80, 16, v35
    v_and_b32 v81, 0xffff0000, v35
    v_add_f32 v78, v78, v80
    v_add_f32 v79, v79, v81
    s_waitcnt vmcnt(6)
    v_lshlrev_b32 v80, 16, v36
    v_and_b32 v81, 0xffff0000, v36
    v_add_f32 v72, v72, v80
    v_add_f32 v73, v73, v81
    v_lshlrev_b32 v80, 16, v37
    v_and_b32 v81, 0xffff0000, v37
    v_add_f32 v74, v74, v80
    v_add_f32 v75, v75, v81
    v_lshlrev_b32 v80, 16, v38
    v_and_b32 v81, 0xffff0000, v38
    v_add_f32 v76, v76, v80
    v_add_f32 v77, v77, v81
    v_lshlrev_b32 v80, 16, v39
    v_and_b32 v81, 0xffff0000, v39
    v_add_f32 v78, v78, v80
    v_add_f32 v79, v79, v81
    s_waitcnt vmcnt(5)
    v_lshlrev_b32 v80, 16, v40
    v_and_b32 v81, 0xffff0000, v40
    v_add_f32 v72, v72, v80
    v_add_f32 v73, v73, v81
    v_lshlrev_b32 v80, 16, v41
    v_and_b32 v81, 0xffff0000, v41
    v_add_f32 v74, v74, v80
    v_add_f32 v75, v75, v81
    v_lshlrev_b32 v80, 16, v42
    v_and_b32 v81, 0xffff0000, v42
    v_add_f32 v76, v76, v80
    v_add_f32 v77, v77, v81
    v_lshlrev_b32 v80, 16, v43
    v_and_b32 v81, 0xffff0000, v43
    v_add_f32 v78, v78, v80
    v_add_f32 v79, v79, v81
    s_waitcnt vmcnt(4)
    v_lshlrev_b32 v80, 16, v44
    v_and_b32 v81, 0xffff0000, v44
    v_add_f32 v72, v72, v80
    v_add_f32 v73, v73, v81
    v_lshlrev_b32 v80, 16, v45
    v_and_b32 v81, 0xffff0000, v45
    v_add_f32 v74, v74, v80
    v_add_f32 v75, v75, v81
    v_lshlrev_b32 v80, 16, v46
    v_and_b32 v81, 0xffff0000, v46
    v_add_f32 v76, v76, v80
    v_add_f32 v77, v77, v81
    v_lshlrev_b32 v80, 16, v47
    v_and_b32 v81, 0xffff0000, v47
    v_add_f32 v78, v78, v80
    v_add_f32 v79, v79, v81
    s_waitcnt vmcnt(3)
    v_lshlrev_b32 v80, 16, v48
    v_and_b32 v81, 0xffff0000, v48
    v_add_f32 v72, v72, v80
    v_add_f32 v73, v73, v81
    v_lshlrev_b32 v80, 16, v49
    v_and_b32 v81, 0xffff0000, v49
    v_add_f32 v74, v74, v80
    v_add_f32 v75, v75, v81
    v_lshlrev_b32 v80, 16, v50
    v_and_b32 v81, 0xffff0000, v50
    v_add_f32 v76, v76, v80
    v_add_f32 v77, v77, v81
    v_lshlrev_b32 v80, 16, v51
    v_and_b32 v81, 0xffff0000, v51
    v_add_f32 v78, v78, v80
    v_add_f32 v79, v79, v81
    s_waitcnt vmcnt(2)
    v_lshlrev_b32 v80, 16, v52
    v_and_b32 v81, 0xffff0000, v52
    v_add_f32 v72, v72, v80
    v_add_f32 v73, v73, v81
    v_lshlrev_b32 v80, 16, v53
    v_and_b32 v81, 0xffff0000, v53
    v_add_f32 v74, v74, v80
    v_add_f32 v75, v75, v81
    v_lshlrev_b32 v80, 16, v54
    v_and_b32 v81, 0xffff0000, v54
    v_add_f32 v76, v76, v80
    v_add_f32 v77, v77, v81
    v_lshlrev_b32 v80, 16, v55
    v_and_b32 v81, 0xffff0000, v55
    v_add_f32 v78, v78, v80
    v_add_f32 v79, v79, v81
    s_waitcnt vmcnt(1)
    v_lshlrev_b32 v80, 16, v56
    v_and_b32 v81, 0xffff0000, v56
    v_add_f32 v72, v72, v80
    v_add_f32 v73, v73, v81
    v_lshlrev_b32 v80, 16, v57
    v_and_b32 v81, 0xffff0000, v57
    v_add_f32 v74, v74, v80
    v_add_f32 v75, v75, v81
    v_lshlrev_b32 v80, 16, v58
    v_and_b32 v81, 0xffff0000, v58
    v_add_f32 v76, v76, v80
    v_add_f32 v77, v77, v81
    v_lshlrev_b32 v80, 16, v59
    v_and_b32 v81, 0xffff0000, v59
    v_add_f32 v78, v78, v80
    v_add_f32 v79, v79, v81
    s_waitcnt vmcnt(0)
    v_lshlrev_b32 v80, 16, v60
    v_and_b32 v81, 0xffff0000, v60
    v_add_f32 v72, v72, v80
    v_add_f32 v73, v73, v81
    v_lshlrev_b32 v80, 16, v61
    v_and_b32 v81, 0xffff0000, v61
    v_add_f32 v74, v74, v80
    v_add_f32 v75, v75, v81
    v_lshlrev_b32 v80, 16, v62
    v_and_b32 v81, 0xffff0000, v62
    v_add_f32 v76, v76, v80
    v_add_f32 v77, v77, v81
    v_lshlrev_b32 v80, 16, v63
    v_and_b32 v81, 0xffff0000, v63
    v_add_f32 v78, v78, v80
    v_add_f32 v79, v79, v81
    s_lshl_b32 s65, s32, 2
    v_add_u32 v5, s65, v2
    v_lshlrev_b32 v5, 9, v5
    v_lshl_add_u32 v5, v3, 5, v5
    ds_write_b128 v5, v[72:75]
    ds_write_b128 v5, v[76:79] offset:16
    s_waitcnt lgkmcnt(0)
    s_barrier
    v_lshlrev_b32 v5, 2, v0
    v_cmp_gt_u32 vcc, 112, v0
    s_nop 3
    s_and_saveexec_b64 s[64:65], vcc
    s_cbranch_execz L_h_cs_done
    ds_read_b32 v8, v5 offset:0
    ds_read_b32 v9, v5 offset:512
    ds_read_b32 v10, v5 offset:1024
    ds_read_b32 v11, v5 offset:1536
    ds_read_b32 v12, v5 offset:2048
    ds_read_b32 v13, v5 offset:2560
    ds_read_b32 v14, v5 offset:3072
    ds_read_b32 v15, v5 offset:3584
    ds_read_b32 v16, v5 offset:4096
    ds_read_b32 v17, v5 offset:4608
    ds_read_b32 v18, v5 offset:5120
    ds_read_b32 v19, v5 offset:5632
    ds_read_b32 v20, v5 offset:6144
    ds_read_b32 v21, v5 offset:6656
    ds_read_b32 v22, v5 offset:7168
    ds_read_b32 v23, v5 offset:7680
    ds_read_b32 v24, v5 offset:8192
    ds_read_b32 v25, v5 offset:8704
    ds_read_b32 v26, v5 offset:9216
    ds_read_b32 v27, v5 offset:9728
    ds_read_b32 v28, v5 offset:10240
    ds_read_b32 v29, v5 offset:10752
    ds_read_b32 v30, v5 offset:11264
    ds_read_b32 v31, v5 offset:11776
    ds_read_b32 v32, v5 offset:12288
    ds_read_b32 v33, v5 offset:12800
    ds_read_b32 v34, v5 offset:13312
    ds_read_b32 v35, v5 offset:13824
    ds_read_b32 v36, v5 offset:14336
    ds_read_b32 v37, v5 offset:14848
    ds_read_b32 v38, v5 offset:15360
    ds_read_b32 v39, v5 offset:15872
    s_waitcnt lgkmcnt(0)
    v_add_f32 v8, v8, v9
    v_add_f32 v8, v8, v10
    v_add_f32 v8, v8, v11
    v_add_f32 v8, v8, v12
    v_add_f32 v8, v8, v13
    v_add_f32 v8, v8, v14
    v_add_f32 v8, v8, v15
    v_add_f32 v8, v8, v16
    v_add_f32 v8, v8, v17
    v_add_f32 v8, v8, v18
    v_add_f32 v8, v8, v19
    v_add_f32 v8, v8, v20
    v_add_f32 v8, v8, v21
    v_add_f32 v8, v8, v22
    v_add_f32 v8, v8, v23
    v_add_f32 v8, v8, v24
    v_add_f32 v8, v8, v25
    v_add_f32 v8, v8, v26
    v_add_f32 v8, v8, v27
    v_add_f32 v8, v8, v28
    v_add_f32 v8, v8, v29
    v_add_f32 v8, v8, v30
    v_add_f32 v8, v8, v31
    v_add_f32 v8, v8, v32
    v_add_f32 v8, v8, v33
    v_add_f32 v8, v8, v34
    v_add_f32 v8, v8, v35
    v_add_f32 v8, v8, v36
    v_add_f32 v8, v8, v37
    v_add_f32 v8, v8, v38
    v_add_f32 v8, v8, v39
    s_mul_i32 s66, s70, 448
    s_add_u32 s66, s66, 32768
    v_add_u32 v5, s66, v5
    buffer_store_dword v8, v5, s[56:59], 0 offen sc1
L_h_cs_done:
    s_mov_b64 exec, s[64:65]
    s_waitcnt vmcnt(0)
    s_barrier
    s_lshl_b32 s64, s70, 6
    s_add_u32 s64, s64, 116736
    s_cmp_eq_u32 s32, 0
    s_cbranch_scc0 L_pub_4336
    v_mov_b32 v2, s33
    v_mov_b32 v3, s64
    s_mov_b64 exec, 1
    buffer_store_dword v2, v3, s[56:59], 0 offen sc1
    s_mov_b64 exec, -1
L_pub_4336:
    s_mov_b32 s64, 65536
    s_cmp_eq_u32 s32, 0
    s_cbranch_scc0 L_pi_hs2
    v_lshlrev_b32 v32, 6, v1
    v_add_u32 v32, s64, v32
    v_add_u32 v37, 192, v1
    v_min_u32 v37, 223, v37
    v_lshlrev_b32 v37, 6, v37
    v_add_u32 v37, s64, v37
    buffer_load_dword v33, v32, s[56:59], 0 offen sc1
    s_mov_b32 s67, 4096
    buffer_load_dword v34, v32, s[56:59], s67 offen sc1
    s_mov_b32 s67, 8192
    buffer_load_dword v35, v32, s[56:59], s67 offen sc1
    buffer_load_dword v36, v37, s[56:59], 0 offen sc1
L_pi_hs2:
    s_waitcnt vmcnt(0)
    s_cmp_eq_u32 s32, 0
    s_cbranch_scc0 L_pc_hs2_bar
    s_mov_b32 s66, 0
L_pc_hs2:
    v_xor_b32 v33, s33, v33
    v_xor_b32 v34, s33, v34
    v_or_b32 v33, v33, v34
    v_xor_b32 v35, s33, v35
    v_or_b32 v33, v33, v35
    v_xor_b32 v36, s33, v36
    v_or_b32 v33, v33, v36
    v_cmp_ne_u32 vcc, 0, v33
    s_cbranch_vccz L_pc_hs2_bar
    s_add_u32 s66, s66, 1
    s_cmp_gt_u32 s66, 30000
    s_cbranch_scc1 L_pc_hs2_bar
    buffer_load_dword v33, v32, s[56:59], 0 offen sc1
    s_mov_b32 s67, 4096
    buffer_load_dword v34, v32, s[56:59], s67 offen sc1
    s_mov_b32 s67, 8192
    buffer_load_dword v35, v32, s[56:59], s67 offen sc1
    buffer_load_dword v36, v37, s[56:59], 0 offen sc1
    s_waitcnt vmcnt(0)
    s_sleep 4
    s_branch L_pc_hs2
L_pc_hs2_bar:
    s_barrier
    v_and_b32 v2, 31, v1
    v_lshrrev_b32 v3, 5, v1
    s_lshl_b32 s64, s32, 1
    v_add_u32 v3, s64, v3
    v_mul_u32_u24 v3, 4352, v3
    v_lshl_add_u32 v3, v2, 2, v3
    s_lshl_b32 s64, s70, 7
    s_add_u32 s64, s64, 131072
    v_add_u32 v3, s64, v3
    s_mov_b32 s67, 0
    buffer_load_dword v40, v3, s[56:59], s67 offen
    s_mov_b32 s67, 69632
    buffer_load_dword v41, v3, s[56:59], s67 offen
    s_mov_b32 s67, 139264
    buffer_load_dword v42, v3, s[56:59], s67 offen
    s_mov_b32 s67, 208896
    buffer_load_dword v43, v3, s[56:59], s67 offen
    s_mov_b32 s67, 278528
    buffer_load_dword v44, v3, s[56:59], s67 offen
    s_mov_b32 s67, 348160
    buffer_load_dword v45, v3, s[56:59], s67 offen
    s_mov_b32 s67, 417792
    buffer_load_dword v46, v3, s[56:59], s67 offen
    s_mov_b32 s67, 487424
    buffer_load_dword v47, v3, s[56:59], s67 offen
    s_mov_b32 s67, 557056
    buffer_load_dword v48, v3, s[56:59], s67 offen
    s_mov_b32 s67, 626688
    buffer_load_dword v49, v3, s[56:59], s67 offen
    s_mov_b32 s67, 696320
    buffer_load_dword v50, v3, s[56:59], s67 offen
    s_mov_b32 s67, 765952
    buffer_load_dword v51, v3, s[56:59], s67 offen
    s_mov_b32 s67, 835584
    buffer_load_dword v52, v3, s[56:59], s67 offen
    s_mov_b32 s67, 905216
    buffer_load_dword v53, v3, s[56:59], s67 offen
    s_mov_b32 s67, 974848
    buffer_load_dword v54, v3, s[56:59], s67 offen
    s_mov_b32 s67, 1044480
    buffer_load_dword v55, v3, s[56:59], s67 offen
    s_mov_b32 s67, 1114112
    buffer_load_dword v56, v3, s[56:59], s67 offen
    s_mov_b32 s67, 1183744
    buffer_load_dword v57, v3, s[56:59], s67 offen
    s_mov_b32 s67, 1253376
    buffer_load_dword v58, v3, s[56:59], s67 offen
    s_mov_b32 s67, 1323008
    buffer_load_dword v59, v3, s[56:59], s67 offen
    s_mov_b32 s67, 1392640
    buffer_load_dword v60, v3, s[56:59], s67 offen
    s_mov_b32 s67, 1462272
    buffer_load_dword v61, v3, s[56:59], s67 offen
    s_mov_b32 s67, 1531904
    buffer_load_dword v62, v3, s[56:59], s67 offen
    s_mov_b32 s67, 1601536
    buffer_load_dword v63, v3, s[56:59], s67 offen
    s_mov_b32 s67, 1671168
    buffer_load_dword v64, v3, s[56:59], s67 offen
    s_mov_b32 s67, 1740800
    buffer_load_dword v65, v3, s[56:59], s67 offen
    s_mov_b32 s67, 1810432
    buffer_load_dword v66, v3, s[56:59], s67 offen
    s_mov_b32 s67, 1880064
    buffer_load_dword v67, v3, s[56:59], s67 offen
    v_mov_b32 v8, 0
    v_mov_b32 v9, 0
    v_mov_b32 v10, 0
    v_mov_b32 v11, 0
    s_waitcnt vmcnt(27)
    v_lshlrev_b32 v12, 16, v40
    v_and_b32 v13, 0xffff0000, v40
    v_add_f32 v8, v8, v12
    v_add_f32 v9, v9, v13
    v_fma_f32 v10, v12, v12, v10
    v_fma_f32 v11, v13, v13, v11
    s_waitcnt vmcnt(26)
    v_lshlrev_b32 v12, 16, v41
    v_and_b32 v13, 0xffff0000, v41
    v_add_f32 v8, v8, v12
    v_add_f32 v9, v9, v13
    v_fma_f32 v10, v12, v12, v10
    v_fma_f32 v11, v13, v13, v11
    s_waitcnt vmcnt(25)
    v_lshlrev_b32 v12, 16, v42
    v_and_b32 v13, 0xffff0000, v42
    v_add_f32 v8, v8, v12
    v_add_f32 v9, v9, v13
    v_fma_f32 v10, v12, v12, v10
    v_fma_f32 v11, v13, v13, v11
    s_waitcnt vmcnt(24)
    v_lshlrev_b32 v12, 16, v43
    v_and_b32 v13, 0xffff0000, v43
    v_add_f32 v8, v8, v12
    v_add_f32 v9, v9, v13
    v_fma_f32 v10, v12, v12, v10
    v_fma_f32 v11, v13, v13, v11
    s_waitcnt vmcnt(23)
    v_lshlrev_b32 v12, 16, v44
    v_and_b32 v13, 0xffff0000, v44
    v_add_f32 v8, v8, v12
    v_add_f32 v9, v9, v13
    v_fma_f32 v10, v12, v12, v10
    v_fma_f32 v11, v13, v13, v11
    s_waitcnt vmcnt(22)
    v_lshlrev_b32 v12, 16, v45
    v_and_b32 v13, 0xffff0000, v45
    v_add_f32 v8, v8, v12
    v_add_f32 v9, v9, v13
    v_fma_f32 v10, v12, v12, v10
    v_fma_f32 v11, v13, v13, v11
    s_waitcnt vmcnt(21)
    v_lshlrev_b32 v12, 16, v46
    v_and_b32 v13, 0xffff0000, v46
    v_add_f32 v8, v8, v12
    v_add_f32 v9, v9, v13
    v_fma_f32 v10, v12, v12, v10
    v_fma_f32 v11, v13, v13, v11
    s_waitcnt vmcnt(20)
    v_lshlrev_b32 v12, 16, v47
    v_and_b32 v13, 0xffff0000, v47
    v_add_f32 v8, v8, v12
    v_add_f32 v9, v9, v13
    v_fma_f32 v10, v12, v12, v10
    v_fma_f32 v11, v13, v13, v11
    s_waitcnt vmcnt(19)
    v_lshlrev_b32 v12, 16, v48
    v_and_b32 v13, 0xffff0000, v48
    v_add_f32 v8, v8, v12
    v_add_f32 v9, v9, v13
    v_fma_f32 v10, v12, v12, v10
    v_fma_f32 v11, v13, v13, v11
    s_waitcnt vmcnt(18)
    v_lshlrev_b32 v12, 16, v49
    v_and_b32 v13, 0xffff0000, v49
    v_add_f32 v8, v8, v12
    v_add_f32 v9, v9, v13
    v_fma_f32 v10, v12, v12, v10
    v_fma_f32 v11, v13, v13, v11
    s_waitcnt vmcnt(17)
    v_lshlrev_b32 v12, 16, v50
    v_and_b32 v13, 0xffff0000, v50
    v_add_f32 v8, v8, v12
    v_add_f32 v9, v9, v13
    v_fma_f32 v10, v12, v12, v10
    v_fma_f32 v11, v13, v13, v11
    s_waitcnt vmcnt(16)
    v_lshlrev_b32 v12, 16, v51
    v_and_b32 v13, 0xffff0000, v51
    v_add_f32 v8, v8, v12
    v_add_f32 v9, v9, v13
    v_fma_f32 v10, v12, v12, v10
    v_fma_f32 v11, v13, v13, v11
    s_waitcnt vmcnt(15)
    v_lshlrev_b32 v12, 16, v52
    v_and_b32 v13, 0xffff0000, v52
    v_add_f32 v8, v8, v12
    v_add_f32 v9, v9, v13
    v_fma_f32 v10, v12, v12, v10
    v_fma_f32 v11, v13, v13, v11
    s_waitcnt vmcnt(14)
    v_lshlrev_b32 v12, 16, v53
    v_and_b32 v13, 0xffff0000, v53
    v_add_f32 v8, v8, v12
    v_add_f32 v9, v9, v13
    v_fma_f32 v10, v12, v12, v10
    v_fma_f32 v11, v13, v13, v11
    s_waitcnt vmcnt(13)
    v_lshlrev_b32 v12, 16, v54
    v_and_b32 v13, 0xffff0000, v54
    v_add_f32 v8, v8, v12
    v_add_f32 v9, v9, v13
    v_fma_f32 v10, v12, v12, v10
    v_fma_f32 v11, v13, v13, v11
    s_waitcnt vmcnt(12)
    v_lshlrev_b32 v12, 16, v55
    v_and_b32 v13, 0xffff0000, v55
    v_add_f32 v8, v8, v12
    v_add_f32 v9, v9, v13
    v_fma_f32 v10, v12, v12, v10
    v_fma_f32 v11, v13, v13, v11
    s_waitcnt vmcnt(11)
    v_lshlrev_b32 v12, 16, v56
    v_and_b32 v13, 0xffff0000, v56
    v_add_f32 v8, v8, v12
    v_add_f32 v9, v9, v13
    v_fma_f32 v10, v12, v12, v10
    v_fma_f32 v11, v13, v13, v11
    s_waitcnt vmcnt(10)
    v_lshlrev_b32 v12, 16, v57
    v_and_b32 v13, 0xffff0000, v57
    v_add_f32 v8, v8, v12
    v_add_f32 v9, v9, v13
    v_fma_f32 v10, v12, v12, v10
    v_fma_f32 v11, v13, v13, v11
    s_waitcnt vmcnt(9)
    v_lshlrev_b32 v12, 16, v58
    v_and_b32 v13, 0xffff0000, v58
    v_add_f32 v8, v8, v12
    v_add_f32 v9, v9, v13
    v_fma_f32 v10, v12, v12, v10
    v_fma_f32 v11, v13, v13, v11
    s_waitcnt vmcnt(8)
    v_lshlrev_b32 v12, 16, v59
    v_and_b32 v13, 0xffff0000, v59
    v_add_f32 v8, v8, v12
    v_add_f32 v9, v9, v13
    v_fma_f32 v10, v12, v12, v10
    v_fma_f32 v11, v13, v13, v11
    s_waitcnt vmcnt(7)
    v_lshlrev_b32 v12, 16, v60
    v_and_b32 v13, 0xffff0000, v60
    v_add_f32 v8, v8, v12
    v_add_f32 v9, v9, v13
    v_fma_f32 v10, v12, v12, v10
    v_fma_f32 v11, v13, v13, v11
    s_waitcnt vmcnt(6)
    v_lshlrev_b32 v12, 16, v61
    v_and_b32 v13, 0xffff0000, v61
    v_add_f32 v8, v8, v12
    v_add_f32 v9, v9, v13
    v_fma_f32 v10, v12, v12, v10
    v_fma_f32 v11, v13, v13, v11
    s_waitcnt vmcnt(5)
    v_lshlrev_b32 v12, 16, v62
    v_and_b32 v13, 0xffff0000, v62
    v_add_f32 v8, v8, v12
    v_add_f32 v9, v9, v13
    v_fma_f32 v10, v12, v12, v10
    v_fma_f32 v11, v13, v13, v11
    s_waitcnt vmcnt(4)
    v_lshlrev_b32 v12, 16, v63
    v_and_b32 v13, 0xffff0000, v63
    v_add_f32 v8, v8, v12
    v_add_f32 v9, v9, v13
    v_fma_f32 v10, v12, v12, v10
    v_fma_f32 v11, v13, v13, v11
    s_waitcnt vmcnt(3)
    v_lshlrev_b32 v12, 16, v64
    v_and_b32 v13, 0xffff0000, v64
    v_add_f32 v8, v8, v12
    v_add_f32 v9, v9, v13
    v_fma_f32 v10, v12, v12, v10
    v_fma_f32 v11, v13, v13, v11
    s_waitcnt vmcnt(2)
    v_lshlrev_b32 v12, 16, v65
    v_and_b32 v13, 0xffff0000, v65
    v_add_f32 v8, v8, v12
    v_add_f32 v9, v9, v13
    v_fma_f32 v10, v12, v12, v10
    v_fma_f32 v11, v13, v13, v11
    s_waitcnt vmcnt(1)
    v_lshlrev_b32 v12, 16, v66
    v_and_b32 v13, 0xffff0000, v66
    v_add_f32 v8, v8, v12
    v_add_f32 v9, v9, v13
    v_fma_f32 v10, v12, v12, v10
    v_fma_f32 v11, v13, v13, v11
    s_waitcnt vmcnt(0)
    v_lshlrev_b32 v12, 16, v67
    v_and_b32 v13, 0xffff0000, v67
    v_add_f32 v8, v8, v12
    v_add_f32 v9, v9, v13
    v_fma_f32 v10, v12, v12, v10
    v_fma_f32 v11, v13, v13, v11
    v_mov_b32 v12, v8
    s_nop 1
    v_permlane32_swap_b32 v8, v12
    v_add_f32 v8, v8, v12
    v_mov_b32 v12, v9
    s_nop 1
    v_permlane32_swap_b32 v9, v12
    v_add_f32 v9, v9, v12
    v_mov_b32 v12, v10
    s_nop 1
    v_permlane32_swap_b32 v10, v12
    v_add_f32 v10, v10, v12
    v_mov_b32 v12, v11
    s_nop 1
    v_permlane32_swap_b32 v11, v12
    v_add_f32 v11, v11, v12
    s_lshl_b32 s64, s32, 9
    v_lshl_add_u32 v4, v2, 4, s64
    ds_write_b128 v4, v[8:11]
    s_waitcnt lgkmcnt(0)
    s_barrier
    v_cmp_gt_u32 vcc, 64, v0
    s_nop 3
    s_and_saveexec_b64 s[64:65], vcc
    s_cbranch_execz L_h_g2_done
    v_lshrrev_b32 v4, 1, v0
    v_lshlrev_b32 v4, 4, v4
    v_and_b32 v5, 1, v0
    v_lshl_add_u32 v4, v5, 2, v4
    ds_read_b32 v16, v4 offset:0
    ds_read_b32 v24, v4 offset:8
    ds_read_b32 v17, v4 offset:512
    ds_read_b32 v25, v4 offset:520
    ds_read_b32 v18, v4 offset:1024
    ds_read_b32 v26, v4 offset:1032
    ds_read_b32 v19, v4 offset:1536
    ds_read_b32 v27, v4 offset:1544
    ds_read_b32 v20, v4 offset:2048
    ds_read_b32 v28, v4 offset:2056
    ds_read_b32 v21, v4 offset:2560
    ds_read_b32 v29, v4 offset:2568
    ds_read_b32 v22, v4 offset:3072
    ds_read_b32 v30, v4 offset:3080
    ds_read_b32 v23, v4 offset:3584
    ds_read_b32 v31, v4 offset:3592
    s_waitcnt lgkmcnt(0)
    v_add_f32 v16, v16, v17
    v_add_f32 v24, v24, v25
    v_add_f32 v16, v16, v18
    v_add_f32 v24, v24, v26
    v_add_f32 v16, v16, v19
    v_add_f32 v24, v24, v27
    v_add_f32 v16, v16, v20
    v_add_f32 v24, v24, v28
    v_add_f32 v16, v16, v21
    v_add_f32 v24, v24, v29
    v_add_f32 v16, v16, v22
    v_add_f32 v24, v24, v30
    v_add_f32 v16, v16, v23
    v_add_f32 v24, v24, v31
    v_mul_f32 v16, 0x3b124925, v16
    v_mul_f32 v24, 0x3b124925, v24
    v_fma_f32 v24, -v16, v16, v24
    v_max_f32 v24, 0, v24
    v_cvt_pk_bf16_f32 v34, v24, v16
    v_lshlrev_b32 v35, 16, v34
    v_add_f32 v35, 0x3727c5ac, v35
    v_cvt_pk_bf16_f32 v35, v35, v35
    v_lshlrev_b32 v35, 16, v35
    v_sqrt_f32 v35, v35
    s_nop 0
    v_cvt_pk_bf16_f32 v35, v35, v35
    v_lshrrev_b32 v34, 16, v34
    v_and_b32 v35, 0xffff0000, v35
    v_or_b32 v32, v34, v35
    v_and_b32 v33, 0xffff0000, v32
    v_lshlrev_b32 v32, 16, v32
    v_rcp_f32 v33, v33
    s_lshl_b32 s66, s70, 9
    s_add_u32 s66, s66, 3964928
    v_lshl_add_u32 v4, v0, 3, s66
    buffer_store_dwordx2 v[32:33], v4, s[56:59], 0 offen sc1
L_h_g2_done:
    s_mov_b64 exec, s[64:65]
    s_waitcnt vmcnt(0)
    s_barrier
    s_lshl_b32 s64, s70, 6
    s_add_u32 s64, s64, 114688
    s_cmp_eq_u32 s32, 0
    s_cbranch_scc0 L_pub_4735
    v_mov_b32 v2, s33
    v_mov_b32 v3, s64
    s_mov_b64 exec, 1
    buffer_store_dword v2, v3, s[56:59], 0 offen sc1
    s_mov_b64 exec, -1
L_pub_4735:
    s_waitcnt vmcnt(0)
L_end:
    s_endpgm
KERNEL_END:
.section .rodata,"a"
.p2align 6
.amdhsa_kernel sequential_preLN__ssm_conv_s4d__glu_gated_swiglu__prompt_kernel
  .amdhsa_next_free_vgpr 256
  .amdhsa_next_free_sgpr 102
  .amdhsa_accum_offset 256
  .amdhsa_group_segment_fixed_size 0
  .amdhsa_kernarg_size 112
  .amdhsa_user_sgpr_count 2
  .amdhsa_user_sgpr_kernarg_segment_ptr 1
  .amdhsa_system_sgpr_workgroup_id_x 1
  .amdhsa_float_denorm_mode_32 3
.end_amdhsa_kernel
```
